```python
import torch

def _softmax(x, axis=-1):
    return torch.softmax(x, dim=axis)
def _gelu(x):
    return torch.nn.functional.gelu(x, approximate="tanh")
def _silu(x):
    return torch.nn.functional.silu(x)
def _sigmoid(x):
    return torch.sigmoid(x)
def _layernorm(x, axis=-1, eps=1e-5):
    m = x.mean(dim=axis, keepdim=True)
    v = x.var(dim=axis, keepdim=True, unbiased=False)
    return (x - m) / torch.sqrt(v + eps)
def _scatter_add(tgt, idx, src, axis=0):
    return tgt.clone().index_add_(axis, idx, src)
def _segment_sum(src, seg, n):
    out = torch.zeros((n,) + src.shape[1:], dtype=src.dtype)
    return out.index_add_(0, seg, src)
def _pad(x, pw):
    flat = tuple(v for pair in reversed(pw) for v in pair)
    return torch.nn.functional.pad(x, flat)

kernel_name = 'recurrent_scan__grouped_kv_mqa__swiglu_ffn__prompt'

def setup_inputs():

    _w = (lambda a: (lambda t: t.to(torch.bfloat16) if t.is_floating_point() else t)(torch.as_tensor(a)))
    def _A_setup():
        B, S, D, H = 1, 2048, 640, 32
        Dh = D // H
        return {
            "x": _w((lambda *s: torch.randn(*s, dtype=torch.bfloat16) * 0.05)(B, S, D)),
            "wq": _w((lambda *s: torch.randn(*s, dtype=torch.bfloat16) * 0.05)(D, H * Dh)),
            "wk": _w((lambda *s: torch.randn(*s, dtype=torch.bfloat16) * 0.05)(D, Dh)),
            "wv": _w((lambda *s: torch.randn(*s, dtype=torch.bfloat16) * 0.05)(D, Dh)),
            "wo": _w((lambda *s: torch.randn(*s, dtype=torch.bfloat16) * 0.05)(H * Dh, D)),
        }
    _A_in = _A_setup()

    def _B_setup():
        B, S, D, F = 1, 2048, 640, 1728
        return {
            "x": _w((lambda *s: torch.randn(*s, dtype=torch.bfloat16) * 0.05)(B, S, D)),
            "w_gate": _w((lambda *s: torch.randn(*s, dtype=torch.bfloat16) * 0.05)(D, F)),
            "w_up": _w((lambda *s: torch.randn(*s, dtype=torch.bfloat16) * 0.05)(D, F)),
            "w_down": _w((lambda *s: torch.randn(*s, dtype=torch.bfloat16) * 0.05)(F, D)),
        }
    _B_in = _B_setup()

    return {
        "A_x": _A_in["x"],
        "A_wq": _A_in["wq"],
        "A_wk": _A_in["wk"],
        "A_wv": _A_in["wv"],
        "A_wo": _A_in["wo"],
        "B_x": _B_in["x"],
        "B_w_gate": _B_in["w_gate"],
        "B_w_up": _B_in["w_up"],
        "B_w_down": _B_in["w_down"],
    }

def reference(A_x, A_wq, A_wk, A_wv, A_wo, B_x, B_w_gate, B_w_up, B_w_down):
    def _A_ref(x, wq, wk, wv, wo):
        B, S, D = x.shape
        H = 32
        Dh = D // H
        q = (lambda x, *d: x.permute(*d))((x @ wq).reshape(B, S, H, Dh), 0, 2, 1, 3)
        k = x @ wk
        v = x @ wv
        scores = torch.einsum("bhqd,bkd->bhqk", q, k) * (Dh ** -0.5)
        p = _softmax(scores, axis=-1)
        o = torch.einsum("bhqk,bkd->bhqd", p, v)
        return (lambda x, *d: x.permute(*d))(o, 0, 2, 1, 3).reshape(B, S, H * Dh) @ wo

    def _B_ref(x, w_gate, w_up, w_down):
        g = _silu(x @ w_gate)
        u = x @ w_up
        return (g * u) @ w_down

    x = A_x
    xn = _layernorm(x, axis=-1)
    s = _A_ref(xn, A_wq, A_wk, A_wv, A_wo)
    g = _silu(_B_ref(xn, B_w_gate, B_w_up, B_w_down))
    return x + s * g
```

```asm
; @launch grid=(256,1,1) block=(512,1,1) lds=163840
.amdgcn_target "amdgcn-amd-amdhsa--gfx950"
.text
.globl recurrent_scan__grouped_kv_mqa__swiglu_ffn__prompt_kernel
.p2align 8
.type recurrent_scan__grouped_kv_mqa__swiglu_ffn__prompt_kernel,@function
recurrent_scan__grouped_kv_mqa__swiglu_ffn__prompt_kernel:
  s_cmp_ge_u32 s2, 256
  s_cbranch_scc1 k_exit
  s_load_dwordx16 s[16:31], s[0:1], 0
  s_load_dwordx8 s[32:39], s[0:1], 64
  v_lshrrev_b32 v1, 6, v0
  v_and_b32 v0, 63, v0
  v_readfirstlane_b32 s3, v1
  s_bfe_u32 s6, s2, 0x20001
  s_lshl_b32 s6, s6, 3
  s_bfe_u32 s14, s2, 0x30003
  s_add_u32 s4, s6, s14
  s_and_b32 s6, s2, 1
  s_lshl_b32 s6, s6, 2
  s_lshr_b32 s7, s2, 6
  s_add_u32 s5, s6, s7
  v_lshrrev_b32 v10, 3, v0
  v_and_b32 v11, 7, v0
  v_mul_u32_u24 v12, 1280, v10
  v_lshl_add_u32 v13, v11, 4, v12
  s_add_u32 s85, s3, s5
  s_and_b32 s85, s85, 7
  s_lshl_b32 s6, s4, 3
  s_add_u32 s6, s6, s85
  s_mul_i32 s6, s6, 10240
  s_cmp_lg_u32 s3, 1
  s_cbranch_scc1 ct_skip
  s_getpc_b64 s[76:77]
  s_and_b32 s76, s76, 0xffffff00
  s_lshr_b32 s7, s2, 3
  s_lshl_b32 s7, s7, 10
  v_min_u32 v8, 7, v0
  v_lshl_add_u32 v8, v8, 7, s7
  v_min_u32 v8, code_end-recurrent_scan__grouped_kv_mqa__swiglu_ffn__prompt_kernel-4, v8
  global_load_dword v59, v8, s[76:77]
ct_skip:
  s_waitcnt lgkmcnt(0)
  s_mov_b32 s40, s16
  s_mov_b32 s41, s17
  s_mov_b32 s42, 2621440
  s_mov_b32 s43, 0x20000
  buffer_load_ushort v2, v12, s[40:43], s6 offen
  buffer_load_dwordx4 v[16:19], v13, s[40:43], s6 offen offset:0
  buffer_load_dwordx4 v[20:23], v13, s[40:43], s6 offen offset:128
  buffer_load_dwordx4 v[24:27], v13, s[40:43], s6 offen offset:256
  buffer_load_dwordx4 v[28:31], v13, s[40:43], s6 offen offset:384
  buffer_load_dwordx4 v[32:35], v13, s[40:43], s6 offen offset:512
  buffer_load_dwordx4 v[36:39], v13, s[40:43], s6 offen offset:640
  buffer_load_dwordx4 v[40:43], v13, s[40:43], s6 offen offset:768
  buffer_load_dwordx4 v[44:47], v13, s[40:43], s6 offen offset:896
  buffer_load_dwordx4 v[48:51], v13, s[40:43], s6 offen offset:1024
  buffer_load_dwordx4 v[52:55], v13, s[40:43], s6 offen offset:1152
  s_load_dword s84, s[38:39], 0
  s_mov_b32 s44, s18
  s_mov_b32 s45, s19
  s_mov_b32 s46, 819200
  s_mov_b32 s47, 0x20000
  s_mov_b32 s72, s38
  s_mov_b32 s73, s39
  s_mov_b32 s74, 18874368
  s_mov_b32 s75, 0x20000
  s_mov_b32 s56, s28
  s_mov_b32 s57, s29
  s_mov_b32 s58, 2211840
  s_mov_b32 s59, 0x20000
  s_mov_b32 s60, s30
  s_mov_b32 s61, s31
  s_mov_b32 s62, 2211840
  s_mov_b32 s63, 0x20000
  s_mov_b32 s64, s32
  s_mov_b32 s65, s33
  s_mov_b32 s66, 2211840
  s_mov_b32 s67, 0x20000
  s_mov_b32 s52, s24
  s_mov_b32 s53, s25
  s_mov_b32 s54, 819200
  s_mov_b32 s55, 0x20000
  s_mov_b32 s68, s34
  s_mov_b32 s69, s35
  s_mov_b32 s70, 2621440
  s_mov_b32 s71, 0x20000
  s_and_b32 s6, s5, 1
  s_cmp_eq_u32 s6, 0
  s_cselect_b32 s48, s20, s22
  s_cselect_b32 s49, s21, s23
  s_mov_b32 s50, 25600
  s_mov_b32 s51, 0x20000
  v_mov_b32 v4, 0
  v_mov_b32 v5, 0
  v_mov_b32 v6, 0
  v_mov_b32 v7, 0
  s_mov_b32 s12, 0xffff0000
  v_lshlrev_b32 v14, 4, v0
  s_and_b32 s9, s3, 3
  s_lshl_b32 s10, s9, 14
  s_add_u32 s10, s10, 81920
  s_cmp_ge_u32 s3, 4
  s_cbranch_scc1 pro_g
  s_waitcnt vmcnt(10)
  v_lshlrev_b32 v2, 16, v2
  s_waitcnt vmcnt(9)
  v_lshlrev_b32 v64, 16, v16
  v_and_b32 v65, s12, v16
  v_lshlrev_b32 v66, 16, v17
  v_and_b32 v67, s12, v17
  v_lshlrev_b32 v68, 16, v18
  v_and_b32 v69, s12, v18
  v_lshlrev_b32 v70, 16, v19
  v_and_b32 v71, s12, v19
  v_pk_add_f32 v[64:65], v[64:65], v[2:3] op_sel_hi:[1,0] neg_lo:[0,1] neg_hi:[0,1]
  v_pk_add_f32 v[66:67], v[66:67], v[2:3] op_sel_hi:[1,0] neg_lo:[0,1] neg_hi:[0,1]
  v_pk_add_f32 v[68:69], v[68:69], v[2:3] op_sel_hi:[1,0] neg_lo:[0,1] neg_hi:[0,1]
  v_pk_add_f32 v[70:71], v[70:71], v[2:3] op_sel_hi:[1,0] neg_lo:[0,1] neg_hi:[0,1]
  v_pk_add_f32 v[4:5], v[4:5], v[64:65]
  v_pk_fma_f32 v[6:7], v[64:65], v[64:65], v[6:7]
  v_pk_add_f32 v[4:5], v[4:5], v[66:67]
  v_pk_fma_f32 v[6:7], v[66:67], v[66:67], v[6:7]
  v_pk_add_f32 v[4:5], v[4:5], v[68:69]
  v_pk_fma_f32 v[6:7], v[68:69], v[68:69], v[6:7]
  v_pk_add_f32 v[4:5], v[4:5], v[70:71]
  v_pk_fma_f32 v[6:7], v[70:71], v[70:71], v[6:7]
  s_waitcnt vmcnt(8)
  v_lshlrev_b32 v72, 16, v20
  v_and_b32 v73, s12, v20
  v_lshlrev_b32 v74, 16, v21
  v_and_b32 v75, s12, v21
  v_lshlrev_b32 v76, 16, v22
  v_and_b32 v77, s12, v22
  v_lshlrev_b32 v78, 16, v23
  v_and_b32 v79, s12, v23
  v_pk_add_f32 v[72:73], v[72:73], v[2:3] op_sel_hi:[1,0] neg_lo:[0,1] neg_hi:[0,1]
  v_pk_add_f32 v[74:75], v[74:75], v[2:3] op_sel_hi:[1,0] neg_lo:[0,1] neg_hi:[0,1]
  v_pk_add_f32 v[76:77], v[76:77], v[2:3] op_sel_hi:[1,0] neg_lo:[0,1] neg_hi:[0,1]
  v_pk_add_f32 v[78:79], v[78:79], v[2:3] op_sel_hi:[1,0] neg_lo:[0,1] neg_hi:[0,1]
  v_pk_add_f32 v[4:5], v[4:5], v[72:73]
  v_pk_fma_f32 v[6:7], v[72:73], v[72:73], v[6:7]
  v_pk_add_f32 v[4:5], v[4:5], v[74:75]
  v_pk_fma_f32 v[6:7], v[74:75], v[74:75], v[6:7]
  v_pk_add_f32 v[4:5], v[4:5], v[76:77]
  v_pk_fma_f32 v[6:7], v[76:77], v[76:77], v[6:7]
  v_pk_add_f32 v[4:5], v[4:5], v[78:79]
  v_pk_fma_f32 v[6:7], v[78:79], v[78:79], v[6:7]
  s_waitcnt vmcnt(7)
  v_lshlrev_b32 v80, 16, v24
  v_and_b32 v81, s12, v24
  v_lshlrev_b32 v82, 16, v25
  v_and_b32 v83, s12, v25
  v_lshlrev_b32 v84, 16, v26
  v_and_b32 v85, s12, v26
  v_lshlrev_b32 v86, 16, v27
  v_and_b32 v87, s12, v27
  v_pk_add_f32 v[80:81], v[80:81], v[2:3] op_sel_hi:[1,0] neg_lo:[0,1] neg_hi:[0,1]
  v_pk_add_f32 v[82:83], v[82:83], v[2:3] op_sel_hi:[1,0] neg_lo:[0,1] neg_hi:[0,1]
  v_pk_add_f32 v[84:85], v[84:85], v[2:3] op_sel_hi:[1,0] neg_lo:[0,1] neg_hi:[0,1]
  v_pk_add_f32 v[86:87], v[86:87], v[2:3] op_sel_hi:[1,0] neg_lo:[0,1] neg_hi:[0,1]
  v_pk_add_f32 v[4:5], v[4:5], v[80:81]
  v_pk_fma_f32 v[6:7], v[80:81], v[80:81], v[6:7]
  v_pk_add_f32 v[4:5], v[4:5], v[82:83]
  v_pk_fma_f32 v[6:7], v[82:83], v[82:83], v[6:7]
  v_pk_add_f32 v[4:5], v[4:5], v[84:85]
  v_pk_fma_f32 v[6:7], v[84:85], v[84:85], v[6:7]
  v_pk_add_f32 v[4:5], v[4:5], v[86:87]
  v_pk_fma_f32 v[6:7], v[86:87], v[86:87], v[6:7]
  s_waitcnt vmcnt(6)
  v_lshlrev_b32 v88, 16, v28
  v_and_b32 v89, s12, v28
  v_lshlrev_b32 v90, 16, v29
  v_and_b32 v91, s12, v29
  v_lshlrev_b32 v92, 16, v30
  v_and_b32 v93, s12, v30
  v_lshlrev_b32 v94, 16, v31
  v_and_b32 v95, s12, v31
  v_pk_add_f32 v[88:89], v[88:89], v[2:3] op_sel_hi:[1,0] neg_lo:[0,1] neg_hi:[0,1]
  v_pk_add_f32 v[90:91], v[90:91], v[2:3] op_sel_hi:[1,0] neg_lo:[0,1] neg_hi:[0,1]
  v_pk_add_f32 v[92:93], v[92:93], v[2:3] op_sel_hi:[1,0] neg_lo:[0,1] neg_hi:[0,1]
  v_pk_add_f32 v[94:95], v[94:95], v[2:3] op_sel_hi:[1,0] neg_lo:[0,1] neg_hi:[0,1]
  v_pk_add_f32 v[4:5], v[4:5], v[88:89]
  v_pk_fma_f32 v[6:7], v[88:89], v[88:89], v[6:7]
  v_pk_add_f32 v[4:5], v[4:5], v[90:91]
  v_pk_fma_f32 v[6:7], v[90:91], v[90:91], v[6:7]
  v_pk_add_f32 v[4:5], v[4:5], v[92:93]
  v_pk_fma_f32 v[6:7], v[92:93], v[92:93], v[6:7]
  v_pk_add_f32 v[4:5], v[4:5], v[94:95]
  v_pk_fma_f32 v[6:7], v[94:95], v[94:95], v[6:7]
  s_waitcnt vmcnt(5)
  v_lshlrev_b32 v96, 16, v32
  v_and_b32 v97, s12, v32
  v_lshlrev_b32 v98, 16, v33
  v_and_b32 v99, s12, v33
  v_lshlrev_b32 v100, 16, v34
  v_and_b32 v101, s12, v34
  v_lshlrev_b32 v102, 16, v35
  v_and_b32 v103, s12, v35
  v_pk_add_f32 v[96:97], v[96:97], v[2:3] op_sel_hi:[1,0] neg_lo:[0,1] neg_hi:[0,1]
  v_pk_add_f32 v[98:99], v[98:99], v[2:3] op_sel_hi:[1,0] neg_lo:[0,1] neg_hi:[0,1]
  v_pk_add_f32 v[100:101], v[100:101], v[2:3] op_sel_hi:[1,0] neg_lo:[0,1] neg_hi:[0,1]
  v_pk_add_f32 v[102:103], v[102:103], v[2:3] op_sel_hi:[1,0] neg_lo:[0,1] neg_hi:[0,1]
  v_pk_add_f32 v[4:5], v[4:5], v[96:97]
  v_pk_fma_f32 v[6:7], v[96:97], v[96:97], v[6:7]
  v_pk_add_f32 v[4:5], v[4:5], v[98:99]
  v_pk_fma_f32 v[6:7], v[98:99], v[98:99], v[6:7]
  v_pk_add_f32 v[4:5], v[4:5], v[100:101]
  v_pk_fma_f32 v[6:7], v[100:101], v[100:101], v[6:7]
  v_pk_add_f32 v[4:5], v[4:5], v[102:103]
  v_pk_fma_f32 v[6:7], v[102:103], v[102:103], v[6:7]
  s_waitcnt vmcnt(4)
  v_lshlrev_b32 v104, 16, v36
  v_and_b32 v105, s12, v36
  v_lshlrev_b32 v106, 16, v37
  v_and_b32 v107, s12, v37
  v_lshlrev_b32 v108, 16, v38
  v_and_b32 v109, s12, v38
  v_lshlrev_b32 v110, 16, v39
  v_and_b32 v111, s12, v39
  v_pk_add_f32 v[104:105], v[104:105], v[2:3] op_sel_hi:[1,0] neg_lo:[0,1] neg_hi:[0,1]
  v_pk_add_f32 v[106:107], v[106:107], v[2:3] op_sel_hi:[1,0] neg_lo:[0,1] neg_hi:[0,1]
  v_pk_add_f32 v[108:109], v[108:109], v[2:3] op_sel_hi:[1,0] neg_lo:[0,1] neg_hi:[0,1]
  v_pk_add_f32 v[110:111], v[110:111], v[2:3] op_sel_hi:[1,0] neg_lo:[0,1] neg_hi:[0,1]
  v_pk_add_f32 v[4:5], v[4:5], v[104:105]
  v_pk_fma_f32 v[6:7], v[104:105], v[104:105], v[6:7]
  v_pk_add_f32 v[4:5], v[4:5], v[106:107]
  v_pk_fma_f32 v[6:7], v[106:107], v[106:107], v[6:7]
  v_pk_add_f32 v[4:5], v[4:5], v[108:109]
  v_pk_fma_f32 v[6:7], v[108:109], v[108:109], v[6:7]
  v_pk_add_f32 v[4:5], v[4:5], v[110:111]
  v_pk_fma_f32 v[6:7], v[110:111], v[110:111], v[6:7]
  s_waitcnt vmcnt(3)
  v_lshlrev_b32 v112, 16, v40
  v_and_b32 v113, s12, v40
  v_lshlrev_b32 v114, 16, v41
  v_and_b32 v115, s12, v41
  v_lshlrev_b32 v116, 16, v42
  v_and_b32 v117, s12, v42
  v_lshlrev_b32 v118, 16, v43
  v_and_b32 v119, s12, v43
  v_pk_add_f32 v[112:113], v[112:113], v[2:3] op_sel_hi:[1,0] neg_lo:[0,1] neg_hi:[0,1]
  v_pk_add_f32 v[114:115], v[114:115], v[2:3] op_sel_hi:[1,0] neg_lo:[0,1] neg_hi:[0,1]
  v_pk_add_f32 v[116:117], v[116:117], v[2:3] op_sel_hi:[1,0] neg_lo:[0,1] neg_hi:[0,1]
  v_pk_add_f32 v[118:119], v[118:119], v[2:3] op_sel_hi:[1,0] neg_lo:[0,1] neg_hi:[0,1]
  v_pk_add_f32 v[4:5], v[4:5], v[112:113]
  v_pk_fma_f32 v[6:7], v[112:113], v[112:113], v[6:7]
  v_pk_add_f32 v[4:5], v[4:5], v[114:115]
  v_pk_fma_f32 v[6:7], v[114:115], v[114:115], v[6:7]
  v_pk_add_f32 v[4:5], v[4:5], v[116:117]
  v_pk_fma_f32 v[6:7], v[116:117], v[116:117], v[6:7]
  v_pk_add_f32 v[4:5], v[4:5], v[118:119]
  v_pk_fma_f32 v[6:7], v[118:119], v[118:119], v[6:7]
  s_waitcnt vmcnt(2)
  v_lshlrev_b32 v120, 16, v44
  v_and_b32 v121, s12, v44
  v_lshlrev_b32 v122, 16, v45
  v_and_b32 v123, s12, v45
  v_lshlrev_b32 v124, 16, v46
  v_and_b32 v125, s12, v46
  v_lshlrev_b32 v126, 16, v47
  v_and_b32 v127, s12, v47
  v_pk_add_f32 v[120:121], v[120:121], v[2:3] op_sel_hi:[1,0] neg_lo:[0,1] neg_hi:[0,1]
  v_pk_add_f32 v[122:123], v[122:123], v[2:3] op_sel_hi:[1,0] neg_lo:[0,1] neg_hi:[0,1]
  v_pk_add_f32 v[124:125], v[124:125], v[2:3] op_sel_hi:[1,0] neg_lo:[0,1] neg_hi:[0,1]
  v_pk_add_f32 v[126:127], v[126:127], v[2:3] op_sel_hi:[1,0] neg_lo:[0,1] neg_hi:[0,1]
  v_pk_add_f32 v[4:5], v[4:5], v[120:121]
  v_pk_fma_f32 v[6:7], v[120:121], v[120:121], v[6:7]
  v_pk_add_f32 v[4:5], v[4:5], v[122:123]
  v_pk_fma_f32 v[6:7], v[122:123], v[122:123], v[6:7]
  v_pk_add_f32 v[4:5], v[4:5], v[124:125]
  v_pk_fma_f32 v[6:7], v[124:125], v[124:125], v[6:7]
  v_pk_add_f32 v[4:5], v[4:5], v[126:127]
  v_pk_fma_f32 v[6:7], v[126:127], v[126:127], v[6:7]
  s_waitcnt vmcnt(1)
  v_lshlrev_b32 v128, 16, v48
  v_and_b32 v129, s12, v48
  v_lshlrev_b32 v130, 16, v49
  v_and_b32 v131, s12, v49
  v_lshlrev_b32 v132, 16, v50
  v_and_b32 v133, s12, v50
  v_lshlrev_b32 v134, 16, v51
  v_and_b32 v135, s12, v51
  v_pk_add_f32 v[128:129], v[128:129], v[2:3] op_sel_hi:[1,0] neg_lo:[0,1] neg_hi:[0,1]
  v_pk_add_f32 v[130:131], v[130:131], v[2:3] op_sel_hi:[1,0] neg_lo:[0,1] neg_hi:[0,1]
  v_pk_add_f32 v[132:133], v[132:133], v[2:3] op_sel_hi:[1,0] neg_lo:[0,1] neg_hi:[0,1]
  v_pk_add_f32 v[134:135], v[134:135], v[2:3] op_sel_hi:[1,0] neg_lo:[0,1] neg_hi:[0,1]
  v_pk_add_f32 v[4:5], v[4:5], v[128:129]
  v_pk_fma_f32 v[6:7], v[128:129], v[128:129], v[6:7]
  v_pk_add_f32 v[4:5], v[4:5], v[130:131]
  v_pk_fma_f32 v[6:7], v[130:131], v[130:131], v[6:7]
  v_pk_add_f32 v[4:5], v[4:5], v[132:133]
  v_pk_fma_f32 v[6:7], v[132:133], v[132:133], v[6:7]
  v_pk_add_f32 v[4:5], v[4:5], v[134:135]
  v_pk_fma_f32 v[6:7], v[134:135], v[134:135], v[6:7]
  s_waitcnt vmcnt(0)
  v_lshlrev_b32 v136, 16, v52
  v_and_b32 v137, s12, v52
  v_lshlrev_b32 v138, 16, v53
  v_and_b32 v139, s12, v53
  v_lshlrev_b32 v140, 16, v54
  v_and_b32 v141, s12, v54
  v_lshlrev_b32 v142, 16, v55
  v_and_b32 v143, s12, v55
  v_pk_add_f32 v[136:137], v[136:137], v[2:3] op_sel_hi:[1,0] neg_lo:[0,1] neg_hi:[0,1]
  v_pk_add_f32 v[138:139], v[138:139], v[2:3] op_sel_hi:[1,0] neg_lo:[0,1] neg_hi:[0,1]
  v_pk_add_f32 v[140:141], v[140:141], v[2:3] op_sel_hi:[1,0] neg_lo:[0,1] neg_hi:[0,1]
  v_pk_add_f32 v[142:143], v[142:143], v[2:3] op_sel_hi:[1,0] neg_lo:[0,1] neg_hi:[0,1]
  v_pk_add_f32 v[4:5], v[4:5], v[136:137]
  v_pk_fma_f32 v[6:7], v[136:137], v[136:137], v[6:7]
  v_pk_add_f32 v[4:5], v[4:5], v[138:139]
  v_pk_fma_f32 v[6:7], v[138:139], v[138:139], v[6:7]
  v_pk_add_f32 v[4:5], v[4:5], v[140:141]
  v_pk_fma_f32 v[6:7], v[140:141], v[140:141], v[6:7]
  v_pk_add_f32 v[4:5], v[4:5], v[142:143]
  v_pk_fma_f32 v[6:7], v[142:143], v[142:143], v[6:7]
  v_min_u32 v8, 16, v0
  v_lshlrev_b32 v8, 7, v8
  s_mul_i32 s7, s2, 8640
  s_mul_i32 s8, s9, 2176
  s_add_u32 s7, s7, s8
  buffer_load_dword v56, v8, s[56:59], s7 offen
  v_min_u32 v8, 16, v0
  v_lshlrev_b32 v8, 7, v8
  s_mul_i32 s7, s2, 8640
  s_mul_i32 s8, s9, 2176
  s_add_u32 s7, s7, s8
  buffer_load_dword v57, v8, s[60:63], s7 offen
  v_min_u32 v8, 6, v0
  v_lshlrev_b32 v8, 7, v8
  s_mul_i32 s7, s2, 3200
  s_mul_i32 s8, s9, 896
  s_add_u32 s7, s7, s8
  buffer_load_dword v58, v8, s[44:47], s7 offen
  v_add_f32 v4, v4, v5
  v_add_f32 v6, v6, v7
  s_nop 1
  v_add_f32_dpp v4, v4, v4 quad_perm:[1,0,3,2] row_mask:0xf bank_mask:0xf
  v_add_f32_dpp v6, v6, v6 quad_perm:[1,0,3,2] row_mask:0xf bank_mask:0xf
  s_nop 1
  v_add_f32_dpp v4, v4, v4 quad_perm:[2,3,0,1] row_mask:0xf bank_mask:0xf
  v_add_f32_dpp v6, v6, v6 quad_perm:[2,3,0,1] row_mask:0xf bank_mask:0xf
  s_nop 1
  v_add_f32_dpp v4, v4, v4 row_half_mirror row_mask:0xf bank_mask:0xf
  v_add_f32_dpp v6, v6, v6 row_half_mirror row_mask:0xf bank_mask:0xf
  v_mul_f32 v4, 0x3acccccd, v4
  v_mul_f32 v6, 0x3acccccd, v6
  v_fma_f32 v6, -v4, v4, v6
  v_max_f32 v6, 0, v6
  v_add_f32 v6, 0x3727c5ac, v6
  v_rsq_f32 v6, v6
  s_and_b32 s7, s85, 3
  s_lshl_b32 s7, s7, 3
  v_mul_f32 v4, v4, v6
  v_add_u32 v8, s7, v10
  v_and_b32 v9, 1, v11
  v_lshl_add_u32 v8, v9, 5, v8
  v_xor_b32 v8, v8, v11
  v_lshlrev_b32 v8, 4, v8
  v_lshrrev_b32 v9, 1, v11
  v_lshl_add_u32 v8, v9, 11, v8
  s_lshr_b32 s7, s85, 2
  s_lshl_b32 s7, s7, 10
  v_add_u32 v8, s7, v8
  v_add_u32 v9, 0x10000, v8
  v_pk_fma_f32 v[64:65], v[64:65], v[6:7], v[4:5] op_sel_hi:[1,0,0] neg_lo:[0,0,1] neg_hi:[0,0,1]
  v_pk_fma_f32 v[66:67], v[66:67], v[6:7], v[4:5] op_sel_hi:[1,0,0] neg_lo:[0,0,1] neg_hi:[0,0,1]
  v_pk_fma_f32 v[68:69], v[68:69], v[6:7], v[4:5] op_sel_hi:[1,0,0] neg_lo:[0,0,1] neg_hi:[0,0,1]
  v_pk_fma_f32 v[70:71], v[70:71], v[6:7], v[4:5] op_sel_hi:[1,0,0] neg_lo:[0,0,1] neg_hi:[0,0,1]
  v_cvt_pk_bf16_f32 v16, v64, v65
  v_cvt_pk_bf16_f32 v17, v66, v67
  v_cvt_pk_bf16_f32 v18, v68, v69
  v_cvt_pk_bf16_f32 v19, v70, v71
  ds_write_b128 v8, v[16:19] offset:0
  v_pk_fma_f32 v[72:73], v[72:73], v[6:7], v[4:5] op_sel_hi:[1,0,0] neg_lo:[0,0,1] neg_hi:[0,0,1]
  v_pk_fma_f32 v[74:75], v[74:75], v[6:7], v[4:5] op_sel_hi:[1,0,0] neg_lo:[0,0,1] neg_hi:[0,0,1]
  v_pk_fma_f32 v[76:77], v[76:77], v[6:7], v[4:5] op_sel_hi:[1,0,0] neg_lo:[0,0,1] neg_hi:[0,0,1]
  v_pk_fma_f32 v[78:79], v[78:79], v[6:7], v[4:5] op_sel_hi:[1,0,0] neg_lo:[0,0,1] neg_hi:[0,0,1]
  v_cvt_pk_bf16_f32 v20, v72, v73
  v_cvt_pk_bf16_f32 v21, v74, v75
  v_cvt_pk_bf16_f32 v22, v76, v77
  v_cvt_pk_bf16_f32 v23, v78, v79
  ds_write_b128 v8, v[20:23] offset:8192
  v_pk_fma_f32 v[80:81], v[80:81], v[6:7], v[4:5] op_sel_hi:[1,0,0] neg_lo:[0,0,1] neg_hi:[0,0,1]
  v_pk_fma_f32 v[82:83], v[82:83], v[6:7], v[4:5] op_sel_hi:[1,0,0] neg_lo:[0,0,1] neg_hi:[0,0,1]
  v_pk_fma_f32 v[84:85], v[84:85], v[6:7], v[4:5] op_sel_hi:[1,0,0] neg_lo:[0,0,1] neg_hi:[0,0,1]
  v_pk_fma_f32 v[86:87], v[86:87], v[6:7], v[4:5] op_sel_hi:[1,0,0] neg_lo:[0,0,1] neg_hi:[0,0,1]
  v_cvt_pk_bf16_f32 v24, v80, v81
  v_cvt_pk_bf16_f32 v25, v82, v83
  v_cvt_pk_bf16_f32 v26, v84, v85
  v_cvt_pk_bf16_f32 v27, v86, v87
  ds_write_b128 v8, v[24:27] offset:16384
  v_pk_fma_f32 v[88:89], v[88:89], v[6:7], v[4:5] op_sel_hi:[1,0,0] neg_lo:[0,0,1] neg_hi:[0,0,1]
  v_pk_fma_f32 v[90:91], v[90:91], v[6:7], v[4:5] op_sel_hi:[1,0,0] neg_lo:[0,0,1] neg_hi:[0,0,1]
  v_pk_fma_f32 v[92:93], v[92:93], v[6:7], v[4:5] op_sel_hi:[1,0,0] neg_lo:[0,0,1] neg_hi:[0,0,1]
  v_pk_fma_f32 v[94:95], v[94:95], v[6:7], v[4:5] op_sel_hi:[1,0,0] neg_lo:[0,0,1] neg_hi:[0,0,1]
  v_cvt_pk_bf16_f32 v28, v88, v89
  v_cvt_pk_bf16_f32 v29, v90, v91
  v_cvt_pk_bf16_f32 v30, v92, v93
  v_cvt_pk_bf16_f32 v31, v94, v95
  ds_write_b128 v8, v[28:31] offset:24576
  v_pk_fma_f32 v[96:97], v[96:97], v[6:7], v[4:5] op_sel_hi:[1,0,0] neg_lo:[0,0,1] neg_hi:[0,0,1]
  v_pk_fma_f32 v[98:99], v[98:99], v[6:7], v[4:5] op_sel_hi:[1,0,0] neg_lo:[0,0,1] neg_hi:[0,0,1]
  v_pk_fma_f32 v[100:101], v[100:101], v[6:7], v[4:5] op_sel_hi:[1,0,0] neg_lo:[0,0,1] neg_hi:[0,0,1]
  v_pk_fma_f32 v[102:103], v[102:103], v[6:7], v[4:5] op_sel_hi:[1,0,0] neg_lo:[0,0,1] neg_hi:[0,0,1]
  v_cvt_pk_bf16_f32 v32, v96, v97
  v_cvt_pk_bf16_f32 v33, v98, v99
  v_cvt_pk_bf16_f32 v34, v100, v101
  v_cvt_pk_bf16_f32 v35, v102, v103
  ds_write_b128 v8, v[32:35] offset:32768
  v_pk_fma_f32 v[104:105], v[104:105], v[6:7], v[4:5] op_sel_hi:[1,0,0] neg_lo:[0,0,1] neg_hi:[0,0,1]
  v_pk_fma_f32 v[106:107], v[106:107], v[6:7], v[4:5] op_sel_hi:[1,0,0] neg_lo:[0,0,1] neg_hi:[0,0,1]
  v_pk_fma_f32 v[108:109], v[108:109], v[6:7], v[4:5] op_sel_hi:[1,0,0] neg_lo:[0,0,1] neg_hi:[0,0,1]
  v_pk_fma_f32 v[110:111], v[110:111], v[6:7], v[4:5] op_sel_hi:[1,0,0] neg_lo:[0,0,1] neg_hi:[0,0,1]
  v_cvt_pk_bf16_f32 v36, v104, v105
  v_cvt_pk_bf16_f32 v37, v106, v107
  v_cvt_pk_bf16_f32 v38, v108, v109
  v_cvt_pk_bf16_f32 v39, v110, v111
  ds_write_b128 v8, v[36:39] offset:40960
  v_pk_fma_f32 v[112:113], v[112:113], v[6:7], v[4:5] op_sel_hi:[1,0,0] neg_lo:[0,0,1] neg_hi:[0,0,1]
  v_pk_fma_f32 v[114:115], v[114:115], v[6:7], v[4:5] op_sel_hi:[1,0,0] neg_lo:[0,0,1] neg_hi:[0,0,1]
  v_pk_fma_f32 v[116:117], v[116:117], v[6:7], v[4:5] op_sel_hi:[1,0,0] neg_lo:[0,0,1] neg_hi:[0,0,1]
  v_pk_fma_f32 v[118:119], v[118:119], v[6:7], v[4:5] op_sel_hi:[1,0,0] neg_lo:[0,0,1] neg_hi:[0,0,1]
  v_cvt_pk_bf16_f32 v40, v112, v113
  v_cvt_pk_bf16_f32 v41, v114, v115
  v_cvt_pk_bf16_f32 v42, v116, v117
  v_cvt_pk_bf16_f32 v43, v118, v119
  ds_write_b128 v8, v[40:43] offset:49152
  v_pk_fma_f32 v[120:121], v[120:121], v[6:7], v[4:5] op_sel_hi:[1,0,0] neg_lo:[0,0,1] neg_hi:[0,0,1]
  v_pk_fma_f32 v[122:123], v[122:123], v[6:7], v[4:5] op_sel_hi:[1,0,0] neg_lo:[0,0,1] neg_hi:[0,0,1]
  v_pk_fma_f32 v[124:125], v[124:125], v[6:7], v[4:5] op_sel_hi:[1,0,0] neg_lo:[0,0,1] neg_hi:[0,0,1]
  v_pk_fma_f32 v[126:127], v[126:127], v[6:7], v[4:5] op_sel_hi:[1,0,0] neg_lo:[0,0,1] neg_hi:[0,0,1]
  v_cvt_pk_bf16_f32 v44, v120, v121
  v_cvt_pk_bf16_f32 v45, v122, v123
  v_cvt_pk_bf16_f32 v46, v124, v125
  v_cvt_pk_bf16_f32 v47, v126, v127
  ds_write_b128 v8, v[44:47] offset:57344
  v_pk_fma_f32 v[128:129], v[128:129], v[6:7], v[4:5] op_sel_hi:[1,0,0] neg_lo:[0,0,1] neg_hi:[0,0,1]
  v_pk_fma_f32 v[130:131], v[130:131], v[6:7], v[4:5] op_sel_hi:[1,0,0] neg_lo:[0,0,1] neg_hi:[0,0,1]
  v_pk_fma_f32 v[132:133], v[132:133], v[6:7], v[4:5] op_sel_hi:[1,0,0] neg_lo:[0,0,1] neg_hi:[0,0,1]
  v_pk_fma_f32 v[134:135], v[134:135], v[6:7], v[4:5] op_sel_hi:[1,0,0] neg_lo:[0,0,1] neg_hi:[0,0,1]
  v_cvt_pk_bf16_f32 v48, v128, v129
  v_cvt_pk_bf16_f32 v49, v130, v131
  v_cvt_pk_bf16_f32 v50, v132, v133
  v_cvt_pk_bf16_f32 v51, v134, v135
  ds_write_b128 v9, v[48:51] offset:0
  v_pk_fma_f32 v[136:137], v[136:137], v[6:7], v[4:5] op_sel_hi:[1,0,0] neg_lo:[0,0,1] neg_hi:[0,0,1]
  v_pk_fma_f32 v[138:139], v[138:139], v[6:7], v[4:5] op_sel_hi:[1,0,0] neg_lo:[0,0,1] neg_hi:[0,0,1]
  v_pk_fma_f32 v[140:141], v[140:141], v[6:7], v[4:5] op_sel_hi:[1,0,0] neg_lo:[0,0,1] neg_hi:[0,0,1]
  v_pk_fma_f32 v[142:143], v[142:143], v[6:7], v[4:5] op_sel_hi:[1,0,0] neg_lo:[0,0,1] neg_hi:[0,0,1]
  v_cvt_pk_bf16_f32 v52, v136, v137
  v_cvt_pk_bf16_f32 v53, v138, v139
  v_cvt_pk_bf16_f32 v54, v140, v141
  v_cvt_pk_bf16_f32 v55, v142, v143
  ds_write_b128 v9, v[52:55] offset:8192
  v_lshlrev_b32 v8, 2, v0
  v_add_u32 v8, 162816, v8
  v_mov_b32 v9, 0
  ds_write_b32 v8, v9
  s_waitcnt lgkmcnt(0)
  s_add_u32 s84, s84, 1
  s_mul_i32 s15, s84, 0x9e3779b1
  s_or_b32 s15, s15, 1
  s_barrier
  s_cmp_ge_u32 s3, 2
  s_cbranch_scc1 a_touch
  s_cmp_eq_u32 s3, 1
  s_cbranch_scc1 a_join
  s_setprio 3
  s_mov_b32 m0, 147456
  s_mov_b32 s7, 0
  buffer_load_dwordx4 v14, s[48:51], s7 offen lds
  s_mov_b32 m0, 148480
  s_mov_b32 s7, 1024
  buffer_load_dwordx4 v14, s[48:51], s7 offen lds
  s_mov_b32 m0, 149504
  s_mov_b32 s7, 2048
  buffer_load_dwordx4 v14, s[48:51], s7 offen lds
  s_mov_b32 m0, 150528
  s_mov_b32 s7, 3072
  buffer_load_dwordx4 v14, s[48:51], s7 offen lds
  s_mov_b32 m0, 151552
  s_mov_b32 s7, 4096
  buffer_load_dwordx4 v14, s[48:51], s7 offen lds
  s_mov_b32 m0, 152576
  s_mov_b32 s7, 5120
  buffer_load_dwordx4 v14, s[48:51], s7 offen lds
  s_mov_b32 m0, 153600
  s_mov_b32 s7, 6144
  buffer_load_dwordx4 v14, s[48:51], s7 offen lds
  s_mov_b32 m0, 154624
  s_mov_b32 s7, 7168
  buffer_load_dwordx4 v14, s[48:51], s7 offen lds
  s_mov_b32 m0, 155648
  s_mov_b32 s7, 8192
  buffer_load_dwordx4 v14, s[48:51], s7 offen lds
  s_mov_b32 m0, 156672
  s_mov_b32 s7, 9216
  buffer_load_dwordx4 v14, s[48:51], s7 offen lds
  s_mov_b32 m0, 157696
  s_mov_b32 s7, 10240
  buffer_load_dwordx4 v14, s[48:51], s7 offen lds
  s_mov_b32 m0, 158720
  s_mov_b32 s7, 11264
  buffer_load_dwordx4 v14, s[48:51], s7 offen lds
  s_mov_b32 m0, 159744
  s_mov_b32 s7, 12288
  buffer_load_dwordx4 v14, s[48:51], s7 offen lds
  s_mov_b32 m0, 160768
  s_mov_b32 s7, 13312
  buffer_load_dwordx4 v14, s[48:51], s7 offen lds
  s_mov_b32 m0, 161792
  s_mov_b32 s7, 14336
  buffer_load_dwordx4 v14, s[48:51], s7 offen lds
  v_lshrrev_b32 v10, 4, v0
  v_bfe_u32 v11, v0, 2, 2
  v_lshl_add_u32 v11, v10, 3, v11
  v_mul_u32_u24 v11, 40, v11
  v_and_b32 v12, 3, v0
  v_lshl_add_u32 v12, v12, 3, v11
  v_add_u32 v1, 147456, v12
  v_add_u32 v2, 147488, v11
  s_lshr_b32 s9, s5, 1
  s_and_b32 s10, s9, 1
  s_lshr_b32 s11, s9, 1
  s_lshl_b32 s12, s10, 4
  v_and_b32 v13, 15, v0
  v_add_u32 v13, s12, v13
  v_and_b32 v15, 1, v10
  v_lshl_add_u32 v15, v15, 5, v13
  v_xor_b32 v15, v15, v10
  v_lshrrev_b32 v7, 1, v10
  v_lshlrev_b32 v7, 11, v7
  s_lshl_b32 s12, s11, 10
  v_add_u32 v7, s12, v7
  v_lshl_add_u32 v3, v15, 4, v7
  v_xor_b32 v15, 4, v15
  v_lshl_add_u32 v4, v15, 4, v7
  v_add_u32 v5, 0x10000, v3
  v_add_u32 v6, 0x10000, v4
  s_and_b32 s6, s5, 1
  s_cmp_eq_u32 s6, 1
  s_waitcnt vmcnt(0)
  s_cbranch_scc1 kv_v
  ds_read_b64_tr_b16 v[16:17], v1 offset:0
  ds_read_b64_tr_b16 v[18:19], v1 offset:160
  ds_read_b64_tr_b16 v[20:21], v2 offset:0
  ds_read_b64_tr_b16 v[22:23], v2 offset:160
  ds_read_b128 v[24:27], v3 offset:0
  ds_read_b64_tr_b16 v[28:29], v1 offset:1280
  ds_read_b64_tr_b16 v[30:31], v1 offset:1440
  ds_read_b64_tr_b16 v[32:33], v2 offset:1280
  ds_read_b64_tr_b16 v[34:35], v2 offset:1440
  ds_read_b128 v[36:39], v4 offset:4096
  ds_read_b64_tr_b16 v[40:41], v1 offset:2560
  ds_read_b64_tr_b16 v[42:43], v1 offset:2720
  ds_read_b64_tr_b16 v[44:45], v2 offset:2560
  ds_read_b64_tr_b16 v[46:47], v2 offset:2720
  ds_read_b128 v[48:51], v3 offset:8192
  ds_read_b64_tr_b16 v[52:53], v1 offset:3840
  ds_read_b64_tr_b16 v[54:55], v1 offset:4000
  ds_read_b64_tr_b16 v[56:57], v2 offset:3840
  ds_read_b64_tr_b16 v[58:59], v2 offset:4000
  ds_read_b128 v[60:63], v4 offset:12288
  s_waitcnt lgkmcnt(10)
  v_mfma_f32_16x16x32_bf16 v[112:115], v[16:19], v[24:27], 0
  v_mfma_f32_16x16x32_bf16 v[116:119], v[20:23], v[24:27], 0
  v_mfma_f32_16x16x32_bf16 v[112:115], v[28:31], v[36:39], v[112:115]
  v_mfma_f32_16x16x32_bf16 v[116:119], v[32:35], v[36:39], v[116:119]
  ds_read_b64_tr_b16 v[16:17], v1 offset:5120
  ds_read_b64_tr_b16 v[18:19], v1 offset:5280
  ds_read_b64_tr_b16 v[20:21], v2 offset:5120
  ds_read_b64_tr_b16 v[22:23], v2 offset:5280
  ds_read_b128 v[24:27], v3 offset:16384
  ds_read_b64_tr_b16 v[28:29], v1 offset:6400
  ds_read_b64_tr_b16 v[30:31], v1 offset:6560
  ds_read_b64_tr_b16 v[32:33], v2 offset:6400
  ds_read_b64_tr_b16 v[34:35], v2 offset:6560
  ds_read_b128 v[36:39], v4 offset:20480
  s_waitcnt lgkmcnt(10)
  v_mfma_f32_16x16x32_bf16 v[112:115], v[40:43], v[48:51], v[112:115]
  v_mfma_f32_16x16x32_bf16 v[116:119], v[44:47], v[48:51], v[116:119]
  v_mfma_f32_16x16x32_bf16 v[112:115], v[52:55], v[60:63], v[112:115]
  v_mfma_f32_16x16x32_bf16 v[116:119], v[56:59], v[60:63], v[116:119]
  ds_read_b64_tr_b16 v[40:41], v1 offset:7680
  ds_read_b64_tr_b16 v[42:43], v1 offset:7840
  ds_read_b64_tr_b16 v[44:45], v2 offset:7680
  ds_read_b64_tr_b16 v[46:47], v2 offset:7840
  ds_read_b128 v[48:51], v3 offset:24576
  ds_read_b64_tr_b16 v[52:53], v1 offset:8960
  ds_read_b64_tr_b16 v[54:55], v1 offset:9120
  ds_read_b64_tr_b16 v[56:57], v2 offset:8960
  ds_read_b64_tr_b16 v[58:59], v2 offset:9120
  ds_read_b128 v[60:63], v4 offset:28672
  s_waitcnt lgkmcnt(10)
  v_mfma_f32_16x16x32_bf16 v[112:115], v[16:19], v[24:27], v[112:115]
  v_mfma_f32_16x16x32_bf16 v[116:119], v[20:23], v[24:27], v[116:119]
  v_mfma_f32_16x16x32_bf16 v[112:115], v[28:31], v[36:39], v[112:115]
  v_mfma_f32_16x16x32_bf16 v[116:119], v[32:35], v[36:39], v[116:119]
  ds_read_b64_tr_b16 v[16:17], v1 offset:10240
  ds_read_b64_tr_b16 v[18:19], v1 offset:10400
  ds_read_b64_tr_b16 v[20:21], v2 offset:10240
  ds_read_b64_tr_b16 v[22:23], v2 offset:10400
  ds_read_b128 v[24:27], v3 offset:32768
  ds_read_b64_tr_b16 v[28:29], v1 offset:11520
  ds_read_b64_tr_b16 v[30:31], v1 offset:11680
  ds_read_b64_tr_b16 v[32:33], v2 offset:11520
  ds_read_b64_tr_b16 v[34:35], v2 offset:11680
  ds_read_b128 v[36:39], v4 offset:36864
  s_waitcnt lgkmcnt(10)
  v_mfma_f32_16x16x32_bf16 v[112:115], v[40:43], v[48:51], v[112:115]
  v_mfma_f32_16x16x32_bf16 v[116:119], v[44:47], v[48:51], v[116:119]
  v_mfma_f32_16x16x32_bf16 v[112:115], v[52:55], v[60:63], v[112:115]
  v_mfma_f32_16x16x32_bf16 v[116:119], v[56:59], v[60:63], v[116:119]
  ds_read_b64_tr_b16 v[40:41], v1 offset:12800
  ds_read_b64_tr_b16 v[42:43], v1 offset:12960
  ds_read_b64_tr_b16 v[44:45], v2 offset:12800
  ds_read_b64_tr_b16 v[46:47], v2 offset:12960
  ds_read_b128 v[48:51], v3 offset:40960
  ds_read_b64_tr_b16 v[52:53], v1 offset:14080
  ds_read_b64_tr_b16 v[54:55], v1 offset:14240
  ds_read_b64_tr_b16 v[56:57], v2 offset:14080
  ds_read_b64_tr_b16 v[58:59], v2 offset:14240
  ds_read_b128 v[60:63], v4 offset:45056
  s_waitcnt lgkmcnt(10)
  v_mfma_f32_16x16x32_bf16 v[112:115], v[16:19], v[24:27], v[112:115]
  v_mfma_f32_16x16x32_bf16 v[116:119], v[20:23], v[24:27], v[116:119]
  v_mfma_f32_16x16x32_bf16 v[112:115], v[28:31], v[36:39], v[112:115]
  v_mfma_f32_16x16x32_bf16 v[116:119], v[32:35], v[36:39], v[116:119]
  s_waitcnt lgkmcnt(0)
  s_mov_b32 m0, 147456
  s_mov_b32 s7, 15360
  buffer_load_dwordx4 v14, s[48:51], s7 offen lds
  s_mov_b32 m0, 148480
  s_mov_b32 s7, 16384
  buffer_load_dwordx4 v14, s[48:51], s7 offen lds
  s_mov_b32 m0, 149504
  s_mov_b32 s7, 17408
  buffer_load_dwordx4 v14, s[48:51], s7 offen lds
  s_mov_b32 m0, 150528
  s_mov_b32 s7, 18432
  buffer_load_dwordx4 v14, s[48:51], s7 offen lds
  s_mov_b32 m0, 151552
  s_mov_b32 s7, 19456
  buffer_load_dwordx4 v14, s[48:51], s7 offen lds
  s_mov_b32 m0, 152576
  s_mov_b32 s7, 20480
  buffer_load_dwordx4 v14, s[48:51], s7 offen lds
  s_mov_b32 m0, 153600
  s_mov_b32 s7, 21504
  buffer_load_dwordx4 v14, s[48:51], s7 offen lds
  s_mov_b32 m0, 154624
  s_mov_b32 s7, 22528
  buffer_load_dwordx4 v14, s[48:51], s7 offen lds
  s_mov_b32 m0, 155648
  s_mov_b32 s7, 23552
  buffer_load_dwordx4 v14, s[48:51], s7 offen lds
  s_mov_b32 m0, 156672
  s_mov_b32 s7, 24576
  buffer_load_dwordx4 v14, s[48:51], s7 offen lds
  v_mfma_f32_16x16x32_bf16 v[112:115], v[40:43], v[48:51], v[112:115]
  v_mfma_f32_16x16x32_bf16 v[116:119], v[44:47], v[48:51], v[116:119]
  v_mfma_f32_16x16x32_bf16 v[112:115], v[52:55], v[60:63], v[112:115]
  v_mfma_f32_16x16x32_bf16 v[116:119], v[56:59], v[60:63], v[116:119]
  s_waitcnt vmcnt(0)
  ds_read_b64_tr_b16 v[16:17], v1 offset:0
  ds_read_b64_tr_b16 v[18:19], v1 offset:160
  ds_read_b64_tr_b16 v[20:21], v2 offset:0
  ds_read_b64_tr_b16 v[22:23], v2 offset:160
  ds_read_b128 v[24:27], v3 offset:49152
  ds_read_b64_tr_b16 v[28:29], v1 offset:1280
  ds_read_b64_tr_b16 v[30:31], v1 offset:1440
  ds_read_b64_tr_b16 v[32:33], v2 offset:1280
  ds_read_b64_tr_b16 v[34:35], v2 offset:1440
  ds_read_b128 v[36:39], v4 offset:53248
  ds_read_b64_tr_b16 v[40:41], v1 offset:2560
  ds_read_b64_tr_b16 v[42:43], v1 offset:2720
  ds_read_b64_tr_b16 v[44:45], v2 offset:2560
  ds_read_b64_tr_b16 v[46:47], v2 offset:2720
  ds_read_b128 v[48:51], v3 offset:57344
  ds_read_b64_tr_b16 v[52:53], v1 offset:3840
  ds_read_b64_tr_b16 v[54:55], v1 offset:4000
  ds_read_b64_tr_b16 v[56:57], v2 offset:3840
  ds_read_b64_tr_b16 v[58:59], v2 offset:4000
  ds_read_b128 v[60:63], v4 offset:61440
  s_waitcnt lgkmcnt(10)
  v_mfma_f32_16x16x32_bf16 v[112:115], v[16:19], v[24:27], v[112:115]
  v_mfma_f32_16x16x32_bf16 v[116:119], v[20:23], v[24:27], v[116:119]
  v_mfma_f32_16x16x32_bf16 v[112:115], v[28:31], v[36:39], v[112:115]
  v_mfma_f32_16x16x32_bf16 v[116:119], v[32:35], v[36:39], v[116:119]
  ds_read_b64_tr_b16 v[16:17], v1 offset:5120
  ds_read_b64_tr_b16 v[18:19], v1 offset:5280
  ds_read_b64_tr_b16 v[20:21], v2 offset:5120
  ds_read_b64_tr_b16 v[22:23], v2 offset:5280
  ds_read_b128 v[24:27], v5 offset:0
  ds_read_b64_tr_b16 v[28:29], v1 offset:6400
  ds_read_b64_tr_b16 v[30:31], v1 offset:6560
  ds_read_b64_tr_b16 v[32:33], v2 offset:6400
  ds_read_b64_tr_b16 v[34:35], v2 offset:6560
  ds_read_b128 v[36:39], v6 offset:4096
  s_waitcnt lgkmcnt(10)
  v_mfma_f32_16x16x32_bf16 v[112:115], v[40:43], v[48:51], v[112:115]
  v_mfma_f32_16x16x32_bf16 v[116:119], v[44:47], v[48:51], v[116:119]
  v_mfma_f32_16x16x32_bf16 v[112:115], v[52:55], v[60:63], v[112:115]
  v_mfma_f32_16x16x32_bf16 v[116:119], v[56:59], v[60:63], v[116:119]
  ds_read_b64_tr_b16 v[40:41], v1 offset:7680
  ds_read_b64_tr_b16 v[42:43], v1 offset:7840
  ds_read_b64_tr_b16 v[44:45], v2 offset:7680
  ds_read_b64_tr_b16 v[46:47], v2 offset:7840
  ds_read_b128 v[48:51], v5 offset:8192
  ds_read_b64_tr_b16 v[52:53], v1 offset:8960
  ds_read_b64_tr_b16 v[54:55], v1 offset:9120
  ds_read_b64_tr_b16 v[56:57], v2 offset:8960
  ds_read_b64_tr_b16 v[58:59], v2 offset:9120
  ds_read_b128 v[60:63], v6 offset:12288
  s_waitcnt lgkmcnt(10)
  v_mfma_f32_16x16x32_bf16 v[112:115], v[16:19], v[24:27], v[112:115]
  v_mfma_f32_16x16x32_bf16 v[116:119], v[20:23], v[24:27], v[116:119]
  v_mfma_f32_16x16x32_bf16 v[112:115], v[28:31], v[36:39], v[112:115]
  v_mfma_f32_16x16x32_bf16 v[116:119], v[32:35], v[36:39], v[116:119]
  s_waitcnt lgkmcnt(0)
  v_mfma_f32_16x16x32_bf16 v[112:115], v[40:43], v[48:51], v[112:115]
  v_mfma_f32_16x16x32_bf16 v[116:119], v[44:47], v[48:51], v[116:119]
  v_mfma_f32_16x16x32_bf16 v[112:115], v[52:55], v[60:63], v[112:115]
  v_mfma_f32_16x16x32_bf16 v[116:119], v[56:59], v[60:63], v[116:119]
  s_lshl_b32 s12, s4, 1
  s_add_u32 s12, s12, s11
  s_mul_i32 s12, s12, 3584
  s_add_u32 s12, s12, 65536
  v_lshrrev_b32 v2, 1, v10
  v_lshl_add_u32 v2, v2, 5, v13
  v_lshlrev_b32 v2, 4, v2
  v_and_b32 v3, 1, v10
  v_lshl_add_u32 v2, v3, 3, v2
  v_lshl_add_u32 v3, v10, 5, v13
  v_lshlrev_b32 v3, 3, v3
  v_add_u32 v3, 3072, v3
  v_mov_b32 v4, 2130706432
  v_cmp_lt_u32 vcc, 1, v10
  s_nop 1
  v_cndmask_b32 v3, v3, v4, vcc
  v_mul_f32 v112, 0x3ea52b5c, v112
  v_mul_f32 v113, 0x3ea52b5c, v113
  v_mul_f32 v114, 0x3ea52b5c, v114
  v_mul_f32 v115, 0x3ea52b5c, v115
  v_mul_f32 v116, 0x3ea52b5c, v116
  v_mul_f32 v117, 0x3ea52b5c, v117
  v_mul_f32 v118, 0x3ea52b5c, v118
  v_mul_f32 v119, 0x3ea52b5c, v119
  v_cvt_pk_bf16_f32 v6, v112, v113
  v_cvt_pk_bf16_f32 v7, v114, v115
  v_cvt_pk_bf16_f32 v8, v116, v117
  v_cvt_pk_bf16_f32 v9, v118, v119
  v_cmp_eq_u32 vcc, 1, v10
  v_mov_b32 v4, 0x3f803f80
  v_mov_b32 v5, 0x00003f80
  v_cndmask_b32 v8, v8, v4, vcc
  v_cndmask_b32 v9, v9, v5, vcc
  s_branch kv_store
kv_v:
  ds_read_b64_tr_b16 v[16:17], v1 offset:0
  ds_read_b64_tr_b16 v[18:19], v1 offset:160
  ds_read_b64_tr_b16 v[20:21], v2 offset:0
  ds_read_b64_tr_b16 v[22:23], v2 offset:160
  ds_read_b128 v[24:27], v3 offset:0
  ds_read_b64_tr_b16 v[28:29], v1 offset:1280
  ds_read_b64_tr_b16 v[30:31], v1 offset:1440
  ds_read_b64_tr_b16 v[32:33], v2 offset:1280
  ds_read_b64_tr_b16 v[34:35], v2 offset:1440
  ds_read_b128 v[36:39], v4 offset:4096
  ds_read_b64_tr_b16 v[40:41], v1 offset:2560
  ds_read_b64_tr_b16 v[42:43], v1 offset:2720
  ds_read_b64_tr_b16 v[44:45], v2 offset:2560
  ds_read_b64_tr_b16 v[46:47], v2 offset:2720
  ds_read_b128 v[48:51], v3 offset:8192
  ds_read_b64_tr_b16 v[52:53], v1 offset:3840
  ds_read_b64_tr_b16 v[54:55], v1 offset:4000
  ds_read_b64_tr_b16 v[56:57], v2 offset:3840
  ds_read_b64_tr_b16 v[58:59], v2 offset:4000
  ds_read_b128 v[60:63], v4 offset:12288
  s_waitcnt lgkmcnt(10)
  v_mfma_f32_16x16x32_bf16 v[112:115], v[24:27], v[16:19], 0
  v_mfma_f32_16x16x32_bf16 v[116:119], v[24:27], v[20:23], 0
  v_mfma_f32_16x16x32_bf16 v[112:115], v[36:39], v[28:31], v[112:115]
  v_mfma_f32_16x16x32_bf16 v[116:119], v[36:39], v[32:35], v[116:119]
  ds_read_b64_tr_b16 v[16:17], v1 offset:5120
  ds_read_b64_tr_b16 v[18:19], v1 offset:5280
  ds_read_b64_tr_b16 v[20:21], v2 offset:5120
  ds_read_b64_tr_b16 v[22:23], v2 offset:5280
  ds_read_b128 v[24:27], v3 offset:16384
  ds_read_b64_tr_b16 v[28:29], v1 offset:6400
  ds_read_b64_tr_b16 v[30:31], v1 offset:6560
  ds_read_b64_tr_b16 v[32:33], v2 offset:6400
  ds_read_b64_tr_b16 v[34:35], v2 offset:6560
  ds_read_b128 v[36:39], v4 offset:20480
  s_waitcnt lgkmcnt(10)
  v_mfma_f32_16x16x32_bf16 v[112:115], v[48:51], v[40:43], v[112:115]
  v_mfma_f32_16x16x32_bf16 v[116:119], v[48:51], v[44:47], v[116:119]
  v_mfma_f32_16x16x32_bf16 v[112:115], v[60:63], v[52:55], v[112:115]
  v_mfma_f32_16x16x32_bf16 v[116:119], v[60:63], v[56:59], v[116:119]
  ds_read_b64_tr_b16 v[40:41], v1 offset:7680
  ds_read_b64_tr_b16 v[42:43], v1 offset:7840
  ds_read_b64_tr_b16 v[44:45], v2 offset:7680
  ds_read_b64_tr_b16 v[46:47], v2 offset:7840
  ds_read_b128 v[48:51], v3 offset:24576
  ds_read_b64_tr_b16 v[52:53], v1 offset:8960
  ds_read_b64_tr_b16 v[54:55], v1 offset:9120
  ds_read_b64_tr_b16 v[56:57], v2 offset:8960
  ds_read_b64_tr_b16 v[58:59], v2 offset:9120
  ds_read_b128 v[60:63], v4 offset:28672
  s_waitcnt lgkmcnt(10)
  v_mfma_f32_16x16x32_bf16 v[112:115], v[24:27], v[16:19], v[112:115]
  v_mfma_f32_16x16x32_bf16 v[116:119], v[24:27], v[20:23], v[116:119]
  v_mfma_f32_16x16x32_bf16 v[112:115], v[36:39], v[28:31], v[112:115]
  v_mfma_f32_16x16x32_bf16 v[116:119], v[36:39], v[32:35], v[116:119]
  ds_read_b64_tr_b16 v[16:17], v1 offset:10240
  ds_read_b64_tr_b16 v[18:19], v1 offset:10400
  ds_read_b64_tr_b16 v[20:21], v2 offset:10240
  ds_read_b64_tr_b16 v[22:23], v2 offset:10400
  ds_read_b128 v[24:27], v3 offset:32768
  ds_read_b64_tr_b16 v[28:29], v1 offset:11520
  ds_read_b64_tr_b16 v[30:31], v1 offset:11680
  ds_read_b64_tr_b16 v[32:33], v2 offset:11520
  ds_read_b64_tr_b16 v[34:35], v2 offset:11680
  ds_read_b128 v[36:39], v4 offset:36864
  s_waitcnt lgkmcnt(10)
  v_mfma_f32_16x16x32_bf16 v[112:115], v[48:51], v[40:43], v[112:115]
  v_mfma_f32_16x16x32_bf16 v[116:119], v[48:51], v[44:47], v[116:119]
  v_mfma_f32_16x16x32_bf16 v[112:115], v[60:63], v[52:55], v[112:115]
  v_mfma_f32_16x16x32_bf16 v[116:119], v[60:63], v[56:59], v[116:119]
  ds_read_b64_tr_b16 v[40:41], v1 offset:12800
  ds_read_b64_tr_b16 v[42:43], v1 offset:12960
  ds_read_b64_tr_b16 v[44:45], v2 offset:12800
  ds_read_b64_tr_b16 v[46:47], v2 offset:12960
  ds_read_b128 v[48:51], v3 offset:40960
  ds_read_b64_tr_b16 v[52:53], v1 offset:14080
  ds_read_b64_tr_b16 v[54:55], v1 offset:14240
  ds_read_b64_tr_b16 v[56:57], v2 offset:14080
  ds_read_b64_tr_b16 v[58:59], v2 offset:14240
  ds_read_b128 v[60:63], v4 offset:45056
  s_waitcnt lgkmcnt(10)
  v_mfma_f32_16x16x32_bf16 v[112:115], v[24:27], v[16:19], v[112:115]
  v_mfma_f32_16x16x32_bf16 v[116:119], v[24:27], v[20:23], v[116:119]
  v_mfma_f32_16x16x32_bf16 v[112:115], v[36:39], v[28:31], v[112:115]
  v_mfma_f32_16x16x32_bf16 v[116:119], v[36:39], v[32:35], v[116:119]
  s_waitcnt lgkmcnt(0)
  s_mov_b32 m0, 147456
  s_mov_b32 s7, 15360
  buffer_load_dwordx4 v14, s[48:51], s7 offen lds
  s_mov_b32 m0, 148480
  s_mov_b32 s7, 16384
  buffer_load_dwordx4 v14, s[48:51], s7 offen lds
  s_mov_b32 m0, 149504
  s_mov_b32 s7, 17408
  buffer_load_dwordx4 v14, s[48:51], s7 offen lds
  s_mov_b32 m0, 150528
  s_mov_b32 s7, 18432
  buffer_load_dwordx4 v14, s[48:51], s7 offen lds
  s_mov_b32 m0, 151552
  s_mov_b32 s7, 19456
  buffer_load_dwordx4 v14, s[48:51], s7 offen lds
  s_mov_b32 m0, 152576
  s_mov_b32 s7, 20480
  buffer_load_dwordx4 v14, s[48:51], s7 offen lds
  s_mov_b32 m0, 153600
  s_mov_b32 s7, 21504
  buffer_load_dwordx4 v14, s[48:51], s7 offen lds
  s_mov_b32 m0, 154624
  s_mov_b32 s7, 22528
  buffer_load_dwordx4 v14, s[48:51], s7 offen lds
  s_mov_b32 m0, 155648
  s_mov_b32 s7, 23552
  buffer_load_dwordx4 v14, s[48:51], s7 offen lds
  s_mov_b32 m0, 156672
  s_mov_b32 s7, 24576
  buffer_load_dwordx4 v14, s[48:51], s7 offen lds
  v_mfma_f32_16x16x32_bf16 v[112:115], v[48:51], v[40:43], v[112:115]
  v_mfma_f32_16x16x32_bf16 v[116:119], v[48:51], v[44:47], v[116:119]
  v_mfma_f32_16x16x32_bf16 v[112:115], v[60:63], v[52:55], v[112:115]
  v_mfma_f32_16x16x32_bf16 v[116:119], v[60:63], v[56:59], v[116:119]
  s_waitcnt vmcnt(0)
  ds_read_b64_tr_b16 v[16:17], v1 offset:0
  ds_read_b64_tr_b16 v[18:19], v1 offset:160
  ds_read_b64_tr_b16 v[20:21], v2 offset:0
  ds_read_b64_tr_b16 v[22:23], v2 offset:160
  ds_read_b128 v[24:27], v3 offset:49152
  ds_read_b64_tr_b16 v[28:29], v1 offset:1280
  ds_read_b64_tr_b16 v[30:31], v1 offset:1440
  ds_read_b64_tr_b16 v[32:33], v2 offset:1280
  ds_read_b64_tr_b16 v[34:35], v2 offset:1440
  ds_read_b128 v[36:39], v4 offset:53248
  ds_read_b64_tr_b16 v[40:41], v1 offset:2560
  ds_read_b64_tr_b16 v[42:43], v1 offset:2720
  ds_read_b64_tr_b16 v[44:45], v2 offset:2560
  ds_read_b64_tr_b16 v[46:47], v2 offset:2720
  ds_read_b128 v[48:51], v3 offset:57344
  ds_read_b64_tr_b16 v[52:53], v1 offset:3840
  ds_read_b64_tr_b16 v[54:55], v1 offset:4000
  ds_read_b64_tr_b16 v[56:57], v2 offset:3840
  ds_read_b64_tr_b16 v[58:59], v2 offset:4000
  ds_read_b128 v[60:63], v4 offset:61440
  s_waitcnt lgkmcnt(10)
  v_mfma_f32_16x16x32_bf16 v[112:115], v[24:27], v[16:19], v[112:115]
  v_mfma_f32_16x16x32_bf16 v[116:119], v[24:27], v[20:23], v[116:119]
  v_mfma_f32_16x16x32_bf16 v[112:115], v[36:39], v[28:31], v[112:115]
  v_mfma_f32_16x16x32_bf16 v[116:119], v[36:39], v[32:35], v[116:119]
  ds_read_b64_tr_b16 v[16:17], v1 offset:5120
  ds_read_b64_tr_b16 v[18:19], v1 offset:5280
  ds_read_b64_tr_b16 v[20:21], v2 offset:5120
  ds_read_b64_tr_b16 v[22:23], v2 offset:5280
  ds_read_b128 v[24:27], v5 offset:0
  ds_read_b64_tr_b16 v[28:29], v1 offset:6400
  ds_read_b64_tr_b16 v[30:31], v1 offset:6560
  ds_read_b64_tr_b16 v[32:33], v2 offset:6400
  ds_read_b64_tr_b16 v[34:35], v2 offset:6560
  ds_read_b128 v[36:39], v6 offset:4096
  s_waitcnt lgkmcnt(10)
  v_mfma_f32_16x16x32_bf16 v[112:115], v[48:51], v[40:43], v[112:115]
  v_mfma_f32_16x16x32_bf16 v[116:119], v[48:51], v[44:47], v[116:119]
  v_mfma_f32_16x16x32_bf16 v[112:115], v[60:63], v[52:55], v[112:115]
  v_mfma_f32_16x16x32_bf16 v[116:119], v[60:63], v[56:59], v[116:119]
  ds_read_b64_tr_b16 v[40:41], v1 offset:7680
  ds_read_b64_tr_b16 v[42:43], v1 offset:7840
  ds_read_b64_tr_b16 v[44:45], v2 offset:7680
  ds_read_b64_tr_b16 v[46:47], v2 offset:7840
  ds_read_b128 v[48:51], v5 offset:8192
  ds_read_b64_tr_b16 v[52:53], v1 offset:8960
  ds_read_b64_tr_b16 v[54:55], v1 offset:9120
  ds_read_b64_tr_b16 v[56:57], v2 offset:8960
  ds_read_b64_tr_b16 v[58:59], v2 offset:9120
  ds_read_b128 v[60:63], v6 offset:12288
  s_waitcnt lgkmcnt(10)
  v_mfma_f32_16x16x32_bf16 v[112:115], v[24:27], v[16:19], v[112:115]
  v_mfma_f32_16x16x32_bf16 v[116:119], v[24:27], v[20:23], v[116:119]
  v_mfma_f32_16x16x32_bf16 v[112:115], v[36:39], v[28:31], v[112:115]
  v_mfma_f32_16x16x32_bf16 v[116:119], v[36:39], v[32:35], v[116:119]
  s_waitcnt lgkmcnt(0)
  v_mfma_f32_16x16x32_bf16 v[112:115], v[48:51], v[40:43], v[112:115]
  v_mfma_f32_16x16x32_bf16 v[116:119], v[48:51], v[44:47], v[116:119]
  v_mfma_f32_16x16x32_bf16 v[112:115], v[60:63], v[52:55], v[112:115]
  v_mfma_f32_16x16x32_bf16 v[116:119], v[60:63], v[56:59], v[116:119]
  s_lshl_b32 s12, s4, 1
  s_add_u32 s12, s12, s11
  s_mul_i32 s12, s12, 3584
  s_add_u32 s12, s12, 65536
  v_and_b32 v1, 15, v0
  v_and_b32 v4, 1, v10
  v_lshl_add_u32 v2, v4, 5, v1
  v_lshlrev_b32 v2, 4, v2
  v_lshrrev_b32 v4, 1, v10
  v_lshl_add_u32 v2, v4, 3, v2
  s_lshl_b32 s13, s10, 10
  s_add_u32 s13, s13, 1024
  v_add_u32 v2, s13, v2
  v_add_u32 v3, 256, v2
  v_cvt_pk_bf16_f32 v6, v112, v113
  v_cvt_pk_bf16_f32 v7, v114, v115
  v_cvt_pk_bf16_f32 v8, v116, v117
  v_cvt_pk_bf16_f32 v9, v118, v119
  v_cmp_eq_u32 vcc, 4, v1
  v_mov_b32 v4, 0x3f803f80
  v_mov_b32 v5, 0
  v_cndmask_b32 v4, v5, v4, vcc
  v_cmp_lt_u32 vcc, 3, v1
  s_nop 1
  v_cndmask_b32 v8, v8, v4, vcc
  v_cndmask_b32 v9, v9, v4, vcc
kv_store:
  buffer_store_dwordx2 v[6:7], v2, s[72:75], s12 offen sc1
  buffer_store_dwordx2 v[8:9], v3, s[72:75], s12 offen sc1
  s_waitcnt lgkmcnt(0)
  v_mov_b32 v10, 162816
  v_mov_b32 v11, 1
  s_mov_b64 exec, 1
  ds_add_u32 v10, v11
  s_mov_b64 exec, -1
  s_waitcnt lgkmcnt(0)
  v_mov_b32 v10, 162840
  v_mov_b32 v11, 1
  s_mov_b64 exec, 1
  ds_add_u32 v10, v11
  s_mov_b64 exec, -1
  s_lshl_b32 s12, s4, 3
  s_add_u32 s12, s12, s5
  s_lshl_b32 s12, s12, 2
  s_add_u32 s12, s12, 4096
  v_mov_b32 v10, 0
  v_mov_b32 v11, s15
  s_waitcnt vmcnt(0)
  s_mov_b64 exec, 1
  buffer_store_dword v11, v10, s[72:75], s12 offen sc1
  s_mov_b64 exec, -1
  s_setprio 0
  s_branch a_join
a_touch:
  s_and_b32 s6, s3, 1
  s_waitcnt vmcnt(0)
  v_mov_b32 v10, 162840
  s_mov_b32 s8, 0x40000
lw_1:
  ds_read_b32 v11, v10
  s_waitcnt lgkmcnt(0)
  v_readfirstlane_b32 s7, v11
  s_cmp_ge_u32 s7, 1
  s_cbranch_scc1 lwd_2
  s_sleep 8
  s_sub_u32 s8, s8, 1
  s_cmp_lg_u32 s8, 0
  s_cbranch_scc1 lw_1
lwd_2:
  v_min_u32 v8, 33, v0
  v_lshlrev_b32 v8, 7, v8
  s_mul_i32 s7, s2, 8640
  s_mul_i32 s8, s6, 4352
  s_add_u32 s7, s7, s8
  buffer_load_dword v57, v8, s[64:67], s7 offen
  v_min_u32 v8, 12, v0
  v_lshlrev_b32 v8, 7, v8
  s_mul_i32 s7, s2, 3200
  s_mul_i32 s8, s6, 1664
  s_add_u32 s7, s7, s8
  buffer_load_dword v58, v8, s[52:55], s7 offen
a_join:
  s_mov_b32 s48, s38
  s_mov_b32 s49, s39
  s_mul_i32 s50, s3, 57344
  s_add_u32 s50, s50, 122880
  v_lshlrev_b32 v2, 4, v0
  v_lshlrev_b32 v3, 3, v0
  s_waitcnt vmcnt(0)
  v_mov_b32 v128, 0
  v_mov_b32 v129, 0
  v_mov_b32 v130, 0
  v_mov_b32 v131, 0
  v_mov_b32 v132, 0
  v_mov_b32 v133, 0
  v_mov_b32 v134, 0
  v_mov_b32 v135, 0
  v_mov_b32 v136, 0
  v_mov_b32 v137, 0
  v_mov_b32 v138, 0
  v_mov_b32 v139, 0
  v_mov_b32 v140, 0
  v_mov_b32 v141, 0
  v_mov_b32 v142, 0
  v_mov_b32 v143, 0
  v_mov_b32 v144, 0
  v_mov_b32 v145, 0
  v_mov_b32 v146, 0
  v_mov_b32 v147, 0
  v_mov_b32 v148, 0
  v_mov_b32 v149, 0
  v_mov_b32 v150, 0
  v_mov_b32 v151, 0
  v_mov_b32 v152, 0
  v_mov_b32 v153, 0
  v_mov_b32 v154, 0
  v_mov_b32 v155, 0
  v_mov_b32 v156, 0
  v_mov_b32 v157, 0
  v_mov_b32 v158, 0
  v_mov_b32 v159, 0
  v_mov_b32 v160, 0
  v_mov_b32 v161, 0
  v_mov_b32 v162, 0
  v_mov_b32 v163, 0
  v_mov_b32 v164, 0
  v_mov_b32 v165, 0
  v_mov_b32 v166, 0
  v_mov_b32 v167, 0
  v_mov_b32 v168, 0
  v_mov_b32 v169, 0
  v_mov_b32 v170, 0
  v_mov_b32 v171, 0
  v_mov_b32 v172, 0
  v_mov_b32 v173, 0
  v_mov_b32 v174, 0
  v_mov_b32 v175, 0
  v_mov_b32 v176, 0
  v_mov_b32 v177, 0
  v_mov_b32 v178, 0
  v_mov_b32 v179, 0
  v_mov_b32 v180, 0
  v_mov_b32 v181, 0
  v_mov_b32 v182, 0
  v_mov_b32 v183, 0
  v_mov_b32 v184, 0
  v_mov_b32 v185, 0
  v_mov_b32 v186, 0
  v_mov_b32 v187, 0
  v_mov_b32 v188, 0
  v_mov_b32 v189, 0
  v_mov_b32 v190, 0
  v_mov_b32 v191, 0
  v_mov_b32 v192, 0
  v_mov_b32 v193, 0
  v_mov_b32 v194, 0
  v_mov_b32 v195, 0
  v_mov_b32 v196, 0
  v_mov_b32 v197, 0
  v_mov_b32 v198, 0
  v_mov_b32 v199, 0
  v_mov_b32 v200, 0
  v_mov_b32 v201, 0
  v_mov_b32 v202, 0
  v_mov_b32 v203, 0
  v_mov_b32 v204, 0
  v_mov_b32 v205, 0
  v_mov_b32 v206, 0
  v_mov_b32 v207, 0
  v_mov_b32 v208, 0
  v_mov_b32 v209, 0
  v_mov_b32 v210, 0
  v_mov_b32 v211, 0
  v_mov_b32 v212, 0
  v_mov_b32 v213, 0
  v_mov_b32 v214, 0
  v_mov_b32 v215, 0
  v_mov_b32 v216, 0
  v_mov_b32 v217, 0
  v_mov_b32 v218, 0
  v_mov_b32 v219, 0
  v_mov_b32 v220, 0
  v_mov_b32 v221, 0
  v_mov_b32 v222, 0
  v_mov_b32 v223, 0
  v_mov_b32 v224, 0
  v_mov_b32 v225, 0
  v_mov_b32 v226, 0
  v_mov_b32 v227, 0
  v_mov_b32 v228, 0
  v_mov_b32 v229, 0
  v_mov_b32 v230, 0
  v_mov_b32 v231, 0
  v_mov_b32 v232, 0
  v_mov_b32 v233, 0
  v_mov_b32 v234, 0
  v_mov_b32 v235, 0
  v_mov_b32 v236, 0
  v_mov_b32 v237, 0
  v_mov_b32 v238, 0
  v_mov_b32 v239, 0
  v_mov_b32 v240, 0
  v_mov_b32 v241, 0
  v_mov_b32 v242, 0
  v_mov_b32 v243, 0
  v_mov_b32 v244, 0
  v_mov_b32 v245, 0
  v_mov_b32 v246, 0
  v_mov_b32 v247, 0
  v_mov_b32 v248, 0
  v_mov_b32 v249, 0
  v_mov_b32 v250, 0
  v_mov_b32 v251, 0
  v_mov_b32 v252, 0
  v_mov_b32 v253, 0
  v_mov_b32 v254, 0
  v_mov_b32 v255, 0
  v_mov_b32 v64, 0
  v_mov_b32 v65, 0
  v_mov_b32 v66, 0
  v_mov_b32 v67, 0
  v_mov_b32 v68, 0
  v_mov_b32 v69, 0
  v_mov_b32 v70, 0
  v_mov_b32 v71, 0
  v_mov_b32 v72, 0
  v_mov_b32 v73, 0
  v_mov_b32 v74, 0
  v_mov_b32 v75, 0
  v_mov_b32 v76, 0
  v_mov_b32 v77, 0
  v_mov_b32 v78, 0
  v_mov_b32 v79, 0
  v_mov_b32 v32, 0
  v_mov_b32 v33, 0
  v_mov_b32 v34, 0
  v_mov_b32 v35, 0
  v_mov_b32 v36, 0
  v_mov_b32 v37, 0
  v_mov_b32 v38, 0
  v_mov_b32 v39, 0
  v_mov_b32 v40, 0
  v_mov_b32 v41, 0
  v_mov_b32 v42, 0
  v_mov_b32 v43, 0
  v_mov_b32 v44, 0
  v_mov_b32 v45, 0
  v_mov_b32 v46, 0
  v_mov_b32 v47, 0
  v_and_b32 v6, 31, v0
  v_lshlrev_b32 v6, 4, v6
  v_lshrrev_b32 v7, 5, v0
  v_lshl_add_u32 v7, v7, 9, v6
  v_mov_b32 v8, 2130706432
  v_cmp_gt_u32 vcc, 32, v0
  s_lshl_b32 s8, s5, 2
  s_add_u32 s8, s8, s3
  s_mul_i32 s6, s8, 20
  s_add_u32 s9, s6, 19
  s_lshr_b32 s6, s6, 7
  s_lshr_b32 s9, s9, 7
  v_cndmask_b32 v6, v8, v6, vcc
  v_mov_b32 v12, s6
  v_mov_b32 v13, s9
  v_cndmask_b32 v12, v12, v13, vcc
  v_lshlrev_b32 v12, 7, v12
  s_lshl_b32 s13, s4, 5
  s_add_u32 s13, s13, s8
  s_lshl_b32 s13, s13, 10
  s_add_u32 s13, s13, 17825792
  s_and_b32 s9, s8, 1
  s_mul_i32 s8, s8, 5
  s_lshr_b32 s8, s8, 1
  s_lshl_b32 s8, s8, 9
  s_mul_i32 s6, s4, 81920
  s_add_u32 s8, s8, s6
  s_add_u32 s8, s8, 12582912
  s_lshl_b32 s10, s9, 3
  s_add_u32 s10, s10, s8
  s_mul_i32 s11, s9, 504
  s_add_u32 s11, s11, s8
  s_add_u32 s11, s11, 8
  s_add_u32 s8, s3, 0
  s_and_b32 s8, s8, 3
  s_mul_i32 s8, s8, 3072
  s_add_u32 s8, s8, 147456
  v_add_u32 v8, s8, v2
  s_add_u32 s8, s3, 1
  s_and_b32 s8, s8, 3
  s_mul_i32 s8, s8, 3072
  s_add_u32 s8, s8, 147456
  v_add_u32 v9, s8, v2
  s_add_u32 s8, s3, 2
  s_and_b32 s8, s8, 3
  s_mul_i32 s8, s8, 3072
  s_add_u32 s8, s8, 147456
  v_add_u32 v10, s8, v2
  s_add_u32 s8, s3, 3
  s_and_b32 s8, s8, 3
  s_mul_i32 s8, s8, 3072
  s_add_u32 s8, s8, 147456
  v_add_u32 v11, s8, v2
  v_mov_b32 v14, 162840
  s_mov_b32 s9, 0x40000
lw_3:
  ds_read_b32 v15, v14
  s_waitcnt lgkmcnt(0)
  v_readfirstlane_b32 s8, v15
  s_cmp_ge_u32 s8, 1
  s_cbranch_scc1 lwd_4
  s_sleep 8
  s_sub_u32 s9, s9, 1
  s_cmp_lg_u32 s9, 0
  s_cbranch_scc1 lw_3
lwd_4:
  v_mov_b32 v14, 162856
  s_mov_b32 s9, 0x40000
lw_5:
  ds_read_b32 v15, v14
  s_waitcnt lgkmcnt(0)
  v_readfirstlane_b32 s8, v15
  s_cmp_ge_u32 s8, 1
  s_cbranch_scc1 lwd_6
  s_sleep 8
  s_sub_u32 s9, s9, 1
  s_cmp_lg_u32 s9, 0
  s_cbranch_scc1 lw_5
lwd_6:
  s_setprio 3
  s_lshl_b32 s6, s3, 8
  s_add_u32 s6, s6, 4096
  v_lshlrev_b32 v4, 2, v0
  s_mov_b32 s7, 3000
fp_7:
  buffer_load_dword v5, v4, s[72:75], s6 offen sc1
  s_waitcnt vmcnt(0)
  v_cmp_ne_u32 vcc, s15, v5
  s_cbranch_vccz fpd_8
  s_sleep 16
  s_sub_u32 s7, s7, 1
  s_cmp_lg_u32 s7, 0
  s_cbranch_scc1 fp_7
fpd_8:
  s_mul_i32 s7, s3, 57344
  s_add_u32 s7, s7, 65536
  buffer_load_dwordx4 v[16:19], v2, s[48:51], s7 offen sc1
  buffer_load_dwordx2 v[28:29], v3, s[48:51], s7 offen offset:3072 sc1
  buffer_load_dwordx4 v[20:23], v2, s[48:51], s7 offen offset:1024 sc1
  buffer_load_dwordx4 v[24:27], v2, s[48:51], s7 offen offset:2048 sc1
  s_add_u32 s7, s7, 3584
  v_mov_b32 v14, 162816
  s_mov_b32 s9, 0x40000
lw_9:
  ds_read_b32 v15, v14
  s_waitcnt lgkmcnt(0)
  v_readfirstlane_b32 s8, v15
  s_cmp_ge_u32 s8, 2
  s_cbranch_scc1 lwd_10
  s_sleep 4
  s_sub_u32 s9, s9, 1
  s_cmp_lg_u32 s9, 0
  s_cbranch_scc1 lw_9
lwd_10:
  s_mov_b32 s8, 3000
fp_11:
  buffer_load_dword v5, v12, s[72:75], s13 offen sc1
  s_waitcnt vmcnt(0)
  v_cmp_ne_u32 vcc, s15, v5
  s_cbranch_vccz fpd_12
  s_sleep 8
  s_sub_u32 s8, s8, 1
  s_cmp_lg_u32 s8, 0
  s_cbranch_scc1 fp_11
fpd_12:
  buffer_load_dwordx2 v[104:105], v7, s[72:75], s10 offen sc1
  buffer_load_dwordx2 v[106:107], v7, s[72:75], s11 offen sc1
  buffer_load_dwordx2 v[124:125], v6, s[72:75], s10 offen offset:1024 sc1
  s_add_u32 s10, s10, 40960
  s_add_u32 s11, s11, 40960
  buffer_load_dwordx2 v[108:109], v7, s[72:75], s10 offen sc1
  buffer_load_dwordx2 v[110:111], v7, s[72:75], s11 offen sc1
  buffer_load_dwordx2 v[126:127], v6, s[72:75], s10 offen offset:1024 sc1
  s_waitcnt vmcnt(0)
  ds_write_b128 v8, v[104:107]
  ds_write_b128 v8, v[108:111] offset:1024
  ds_write_b128 v8, v[124:127] offset:2048
  s_waitcnt lgkmcnt(0)
  v_mov_b32 v14, 162844
  v_mov_b32 v15, 1
  s_mov_b64 exec, 1
  ds_add_u32 v14, v15
  s_mov_b64 exec, -1
  v_mov_b32 v14, 162844
  s_mov_b32 s9, 0x40000
lw_13:
  ds_read_b32 v15, v14
  s_waitcnt lgkmcnt(0)
  v_readfirstlane_b32 s8, v15
  s_cmp_ge_u32 s8, 4
  s_cbranch_scc1 lwd_14
  s_sub_u32 s9, s9, 1
  s_cmp_lg_u32 s9, 0
  s_cbranch_scc1 lw_13
lwd_14:
  ds_read_b128 v[80:83], v9
  ds_read_b128 v[112:115], v9 offset:2048
  ds_read_b128 v[84:87], v9 offset:1024
  ds_read_b128 v[88:91], v10
  ds_read_b128 v[116:119], v10 offset:2048
  ds_read_b128 v[92:95], v10 offset:1024
  ds_read_b128 v[96:99], v11
  ds_read_b128 v[120:123], v11 offset:2048
  ds_read_b128 v[100:103], v11 offset:1024
  s_setprio 1
  s_mul_i32 s9, s3, 18432
  v_add_u32 v15, s9, v2
  s_waitcnt lgkmcnt(7)
  s_mov_b32 s78, 0
  s_mov_b32 s79, 0
  s_mov_b32 s80, 4
  s_mov_b32 s83, 0x07060302
att_start:
  v_mfma_f32_32x32x16_bf16 v[48:63], v[16:19], v[80:83], 0
  v_mfma_f32_32x32x8_bf16 v[48:63], v[28:29], v[112:113], v[48:63]
  s_nop 7
  s_nop 2
  s_waitcnt lgkmcnt(0)
  s_mov_b32 s8, 8
.p2align 6
att_loop:
  v_exp_f32 v48, v48
  v_exp_f32 v49, v49
  v_mfma_f32_32x32x16_bf16 v[240:255], v[40:43], v[68:71], v[240:255]
  s_setprio 3
  buffer_load_dwordx4 v[32:35], v2, s[48:51], s7 offen sc1
  buffer_load_dwordx2 v[44:45], v3, s[48:51], s7 offen offset:3072 sc1
  buffer_load_dwordx4 v[36:39], v2, s[48:51], s7 offen offset:1024 sc1
  buffer_load_dwordx4 v[40:43], v2, s[48:51], s7 offen offset:2048 sc1
  s_add_u32 s7, s7, 3584
  s_setprio 1
  v_exp_f32 v50, v50
  v_exp_f32 v51, v51
  v_cvt_pk_bf16_f32 v48, v48, v49
  v_cvt_pk_bf16_f32 v49, v50, v51
  v_mfma_f32_32x32x16_bf16 v[64:79], v[16:19], v[84:87], 0
  v_exp_f32 v52, v52
  v_exp_f32 v53, v53
  v_exp_f32 v54, v54
  v_mfma_f32_32x32x8_bf16 v[64:79], v[28:29], v[114:115], v[64:79]
  v_exp_f32 v55, v55
  v_cvt_pk_bf16_f32 v50, v52, v53
  v_cvt_pk_bf16_f32 v51, v54, v55
  v_exp_f32 v56, v56
  v_exp_f32 v57, v57
  v_mfma_f32_32x32x16_bf16 v[128:143], v[20:23], v[48:51], v[128:143]
  v_exp_f32 v58, v58
  v_exp_f32 v59, v59
  v_cvt_pk_bf16_f32 v52, v56, v57
  v_cvt_pk_bf16_f32 v53, v58, v59
  v_exp_f32 v60, v60
  v_exp_f32 v61, v61
  v_exp_f32 v62, v62
  v_exp_f32 v63, v63
  v_cvt_pk_bf16_f32 v54, v60, v61
  v_cvt_pk_bf16_f32 v55, v62, v63
  v_exp_f32 v64, v64
  v_exp_f32 v65, v65
  v_mfma_f32_32x32x16_bf16 v[128:143], v[24:27], v[52:55], v[128:143]
  v_exp_f32 v66, v66
  v_exp_f32 v67, v67
  v_cvt_pk_bf16_f32 v64, v64, v65
  v_cvt_pk_bf16_f32 v65, v66, v67
  v_mfma_f32_32x32x16_bf16 v[48:63], v[16:19], v[88:91], 0
  v_exp_f32 v68, v68
  v_exp_f32 v69, v69
  v_exp_f32 v70, v70
  v_mfma_f32_32x32x8_bf16 v[48:63], v[28:29], v[116:117], v[48:63]
  v_exp_f32 v71, v71
  v_cvt_pk_bf16_f32 v66, v68, v69
  v_cvt_pk_bf16_f32 v67, v70, v71
  v_exp_f32 v72, v72
  v_exp_f32 v73, v73
  v_mfma_f32_32x32x16_bf16 v[144:159], v[20:23], v[64:67], v[144:159]
  v_exp_f32 v74, v74
  v_exp_f32 v75, v75
  v_cvt_pk_bf16_f32 v68, v72, v73
  v_cvt_pk_bf16_f32 v69, v74, v75
  v_exp_f32 v76, v76
  v_exp_f32 v77, v77
  v_exp_f32 v78, v78
  v_exp_f32 v79, v79
  v_cvt_pk_bf16_f32 v70, v76, v77
  v_cvt_pk_bf16_f32 v71, v78, v79
  v_exp_f32 v48, v48
  v_exp_f32 v49, v49
  v_mfma_f32_32x32x16_bf16 v[144:159], v[24:27], v[68:71], v[144:159]
  v_exp_f32 v50, v50
  v_exp_f32 v51, v51
  v_cvt_pk_bf16_f32 v48, v48, v49
  v_cvt_pk_bf16_f32 v49, v50, v51
  v_mfma_f32_32x32x16_bf16 v[64:79], v[16:19], v[92:95], 0
  v_exp_f32 v52, v52
  v_exp_f32 v53, v53
  v_exp_f32 v54, v54
  v_mfma_f32_32x32x8_bf16 v[64:79], v[28:29], v[118:119], v[64:79]
  v_exp_f32 v55, v55
  v_cvt_pk_bf16_f32 v50, v52, v53
  v_cvt_pk_bf16_f32 v51, v54, v55
  v_exp_f32 v56, v56
  v_exp_f32 v57, v57
  v_mfma_f32_32x32x16_bf16 v[160:175], v[20:23], v[48:51], v[160:175]
  v_exp_f32 v58, v58
  v_exp_f32 v59, v59
  v_cvt_pk_bf16_f32 v52, v56, v57
  v_cvt_pk_bf16_f32 v53, v58, v59
  v_exp_f32 v60, v60
  v_exp_f32 v61, v61
  v_exp_f32 v62, v62
  v_exp_f32 v63, v63
  v_cvt_pk_bf16_f32 v54, v60, v61
  v_cvt_pk_bf16_f32 v55, v62, v63
  v_exp_f32 v64, v64
  v_exp_f32 v65, v65
  v_mfma_f32_32x32x16_bf16 v[160:175], v[24:27], v[52:55], v[160:175]
  v_exp_f32 v66, v66
  v_exp_f32 v67, v67
  v_cvt_pk_bf16_f32 v64, v64, v65
  v_cvt_pk_bf16_f32 v65, v66, v67
  v_mfma_f32_32x32x16_bf16 v[48:63], v[16:19], v[96:99], 0
  v_exp_f32 v68, v68
  v_exp_f32 v69, v69
  v_exp_f32 v70, v70
  v_mfma_f32_32x32x8_bf16 v[48:63], v[28:29], v[120:121], v[48:63]
  v_exp_f32 v71, v71
  v_cvt_pk_bf16_f32 v66, v68, v69
  v_cvt_pk_bf16_f32 v67, v70, v71
  v_exp_f32 v72, v72
  v_exp_f32 v73, v73
  v_mfma_f32_32x32x16_bf16 v[176:191], v[20:23], v[64:67], v[176:191]
  v_exp_f32 v74, v74
  v_exp_f32 v75, v75
  v_cvt_pk_bf16_f32 v68, v72, v73
  v_cvt_pk_bf16_f32 v69, v74, v75
  v_exp_f32 v76, v76
  v_exp_f32 v77, v77
  v_exp_f32 v78, v78
  v_exp_f32 v79, v79
  v_cvt_pk_bf16_f32 v70, v76, v77
  v_cvt_pk_bf16_f32 v71, v78, v79
  v_exp_f32 v48, v48
  v_exp_f32 v49, v49
  v_mfma_f32_32x32x16_bf16 v[176:191], v[24:27], v[68:71], v[176:191]
  v_exp_f32 v50, v50
  v_exp_f32 v51, v51
  v_cvt_pk_bf16_f32 v48, v48, v49
  v_cvt_pk_bf16_f32 v49, v50, v51
  v_mfma_f32_32x32x16_bf16 v[64:79], v[16:19], v[100:103], 0
  v_exp_f32 v52, v52
  v_exp_f32 v53, v53
  v_exp_f32 v54, v54
  v_mfma_f32_32x32x8_bf16 v[64:79], v[28:29], v[122:123], v[64:79]
  v_exp_f32 v55, v55
  v_cvt_pk_bf16_f32 v50, v52, v53
  v_cvt_pk_bf16_f32 v51, v54, v55
  v_exp_f32 v56, v56
  v_exp_f32 v57, v57
  v_mfma_f32_32x32x16_bf16 v[192:207], v[20:23], v[48:51], v[192:207]
  v_exp_f32 v58, v58
  v_exp_f32 v59, v59
  v_cvt_pk_bf16_f32 v52, v56, v57
  v_cvt_pk_bf16_f32 v53, v58, v59
  v_exp_f32 v60, v60
  v_exp_f32 v61, v61
  v_exp_f32 v62, v62
  v_exp_f32 v63, v63
  v_cvt_pk_bf16_f32 v54, v60, v61
  v_cvt_pk_bf16_f32 v55, v62, v63
  v_exp_f32 v64, v64
  v_exp_f32 v65, v65
  v_mfma_f32_32x32x16_bf16 v[192:207], v[24:27], v[52:55], v[192:207]
  v_exp_f32 v66, v66
  v_exp_f32 v67, v67
  v_cvt_pk_bf16_f32 v64, v64, v65
  v_cvt_pk_bf16_f32 v65, v66, v67
  v_mfma_f32_32x32x16_bf16 v[48:63], v[16:19], v[104:107], 0
  v_exp_f32 v68, v68
  v_exp_f32 v69, v69
  v_exp_f32 v70, v70
  v_mfma_f32_32x32x8_bf16 v[48:63], v[28:29], v[124:125], v[48:63]
  v_exp_f32 v71, v71
  v_cvt_pk_bf16_f32 v66, v68, v69
  v_cvt_pk_bf16_f32 v67, v70, v71
  v_exp_f32 v72, v72
  v_exp_f32 v73, v73
  v_mfma_f32_32x32x16_bf16 v[208:223], v[20:23], v[64:67], v[208:223]
  v_exp_f32 v74, v74
  v_exp_f32 v75, v75
  v_cvt_pk_bf16_f32 v68, v72, v73
  v_cvt_pk_bf16_f32 v69, v74, v75
  v_exp_f32 v76, v76
  v_exp_f32 v77, v77
  v_exp_f32 v78, v78
  v_exp_f32 v79, v79
  v_cvt_pk_bf16_f32 v70, v76, v77
  v_cvt_pk_bf16_f32 v71, v78, v79
  v_exp_f32 v48, v48
  v_exp_f32 v49, v49
  v_mfma_f32_32x32x16_bf16 v[208:223], v[24:27], v[68:71], v[208:223]
  v_exp_f32 v50, v50
  v_exp_f32 v51, v51
  v_cvt_pk_bf16_f32 v48, v48, v49
  v_cvt_pk_bf16_f32 v49, v50, v51
  v_mfma_f32_32x32x16_bf16 v[64:79], v[16:19], v[108:111], 0
  v_exp_f32 v52, v52
  v_exp_f32 v53, v53
  v_exp_f32 v54, v54
  v_mfma_f32_32x32x8_bf16 v[64:79], v[28:29], v[126:127], v[64:79]
  v_exp_f32 v55, v55
  v_cvt_pk_bf16_f32 v50, v52, v53
  v_cvt_pk_bf16_f32 v51, v54, v55
  v_exp_f32 v56, v56
  v_exp_f32 v57, v57
  v_mfma_f32_32x32x16_bf16 v[224:239], v[20:23], v[48:51], v[224:239]
  v_exp_f32 v58, v58
  v_exp_f32 v59, v59
  v_cvt_pk_bf16_f32 v52, v56, v57
  v_cvt_pk_bf16_f32 v53, v58, v59
  v_exp_f32 v60, v60
  v_exp_f32 v61, v61
  v_exp_f32 v62, v62
  v_exp_f32 v63, v63
  v_cvt_pk_bf16_f32 v54, v60, v61
  v_cvt_pk_bf16_f32 v55, v62, v63
  v_exp_f32 v64, v64
  v_exp_f32 v65, v65
  v_mfma_f32_32x32x16_bf16 v[224:239], v[24:27], v[52:55], v[224:239]
  v_exp_f32 v66, v66
  v_exp_f32 v67, v67
  v_cvt_pk_bf16_f32 v64, v64, v65
  v_cvt_pk_bf16_f32 v65, v66, v67
  s_waitcnt vmcnt(0)
  v_mfma_f32_32x32x16_bf16 v[48:63], v[32:35], v[80:83], 0
  v_exp_f32 v68, v68
  v_exp_f32 v69, v69
  v_exp_f32 v70, v70
  v_mfma_f32_32x32x8_bf16 v[48:63], v[44:45], v[112:113], v[48:63]
  v_exp_f32 v71, v71
  v_cvt_pk_bf16_f32 v66, v68, v69
  v_cvt_pk_bf16_f32 v67, v70, v71
  v_exp_f32 v72, v72
  v_exp_f32 v73, v73
  v_mfma_f32_32x32x16_bf16 v[240:255], v[20:23], v[64:67], v[240:255]
  v_exp_f32 v74, v74
  v_exp_f32 v75, v75
  v_cvt_pk_bf16_f32 v68, v72, v73
  v_cvt_pk_bf16_f32 v69, v74, v75
  v_exp_f32 v76, v76
  v_exp_f32 v77, v77
  v_exp_f32 v78, v78
  v_exp_f32 v79, v79
  v_cvt_pk_bf16_f32 v70, v76, v77
  v_cvt_pk_bf16_f32 v71, v78, v79
  s_cmp_eq_u32 s8, 1
  s_cbranch_scc1 att_last
  v_exp_f32 v48, v48
  v_exp_f32 v49, v49
  v_mfma_f32_32x32x16_bf16 v[240:255], v[24:27], v[68:71], v[240:255]
  s_setprio 3
  buffer_load_dwordx4 v[16:19], v2, s[48:51], s7 offen sc1
  buffer_load_dwordx2 v[28:29], v3, s[48:51], s7 offen offset:3072 sc1
  buffer_load_dwordx4 v[20:23], v2, s[48:51], s7 offen offset:1024 sc1
  buffer_load_dwordx4 v[24:27], v2, s[48:51], s7 offen offset:2048 sc1
  s_add_u32 s7, s7, 3584
  s_setprio 1
  v_exp_f32 v50, v50
  v_exp_f32 v51, v51
  v_cvt_pk_bf16_f32 v48, v48, v49
  v_cvt_pk_bf16_f32 v49, v50, v51
  v_mfma_f32_32x32x16_bf16 v[64:79], v[32:35], v[84:87], 0
  v_exp_f32 v52, v52
  v_exp_f32 v53, v53
  v_exp_f32 v54, v54
  v_mfma_f32_32x32x8_bf16 v[64:79], v[44:45], v[114:115], v[64:79]
  v_exp_f32 v55, v55
  v_cvt_pk_bf16_f32 v50, v52, v53
  v_cvt_pk_bf16_f32 v51, v54, v55
  v_exp_f32 v56, v56
  v_exp_f32 v57, v57
  v_mfma_f32_32x32x16_bf16 v[128:143], v[36:39], v[48:51], v[128:143]
  v_exp_f32 v58, v58
  v_exp_f32 v59, v59
  v_cvt_pk_bf16_f32 v52, v56, v57
  v_cvt_pk_bf16_f32 v53, v58, v59
  v_exp_f32 v60, v60
  v_exp_f32 v61, v61
  v_exp_f32 v62, v62
  v_exp_f32 v63, v63
  v_cvt_pk_bf16_f32 v54, v60, v61
  v_cvt_pk_bf16_f32 v55, v62, v63
  v_exp_f32 v64, v64
  v_exp_f32 v65, v65
  v_mfma_f32_32x32x16_bf16 v[128:143], v[40:43], v[52:55], v[128:143]
  v_exp_f32 v66, v66
  v_exp_f32 v67, v67
  v_cvt_pk_bf16_f32 v64, v64, v65
  v_cvt_pk_bf16_f32 v65, v66, v67
  v_mfma_f32_32x32x16_bf16 v[48:63], v[32:35], v[88:91], 0
  v_exp_f32 v68, v68
  v_exp_f32 v69, v69
  v_exp_f32 v70, v70
  v_mfma_f32_32x32x8_bf16 v[48:63], v[44:45], v[116:117], v[48:63]
  v_exp_f32 v71, v71
  v_cvt_pk_bf16_f32 v66, v68, v69
  v_cvt_pk_bf16_f32 v67, v70, v71
  v_exp_f32 v72, v72
  v_exp_f32 v73, v73
  v_mfma_f32_32x32x16_bf16 v[144:159], v[36:39], v[64:67], v[144:159]
  v_exp_f32 v74, v74
  v_exp_f32 v75, v75
  v_cvt_pk_bf16_f32 v68, v72, v73
  v_cvt_pk_bf16_f32 v69, v74, v75
  v_exp_f32 v76, v76
  v_exp_f32 v77, v77
  v_exp_f32 v78, v78
  v_exp_f32 v79, v79
  v_cvt_pk_bf16_f32 v70, v76, v77
  v_cvt_pk_bf16_f32 v71, v78, v79
  v_exp_f32 v48, v48
  v_exp_f32 v49, v49
  v_mfma_f32_32x32x16_bf16 v[144:159], v[40:43], v[68:71], v[144:159]
  v_exp_f32 v50, v50
  v_exp_f32 v51, v51
  v_cvt_pk_bf16_f32 v48, v48, v49
  v_cvt_pk_bf16_f32 v49, v50, v51
  v_mfma_f32_32x32x16_bf16 v[64:79], v[32:35], v[92:95], 0
  v_exp_f32 v52, v52
  v_exp_f32 v53, v53
  v_exp_f32 v54, v54
  v_mfma_f32_32x32x8_bf16 v[64:79], v[44:45], v[118:119], v[64:79]
  v_exp_f32 v55, v55
  v_cvt_pk_bf16_f32 v50, v52, v53
  v_cvt_pk_bf16_f32 v51, v54, v55
  v_exp_f32 v56, v56
  v_exp_f32 v57, v57
  v_mfma_f32_32x32x16_bf16 v[160:175], v[36:39], v[48:51], v[160:175]
  v_exp_f32 v58, v58
  v_exp_f32 v59, v59
  v_cvt_pk_bf16_f32 v52, v56, v57
  v_cvt_pk_bf16_f32 v53, v58, v59
  v_exp_f32 v60, v60
  v_exp_f32 v61, v61
  v_exp_f32 v62, v62
  v_exp_f32 v63, v63
  v_cvt_pk_bf16_f32 v54, v60, v61
  v_cvt_pk_bf16_f32 v55, v62, v63
  v_exp_f32 v64, v64
  v_exp_f32 v65, v65
  v_mfma_f32_32x32x16_bf16 v[160:175], v[40:43], v[52:55], v[160:175]
  v_exp_f32 v66, v66
  v_exp_f32 v67, v67
  v_cvt_pk_bf16_f32 v64, v64, v65
  v_cvt_pk_bf16_f32 v65, v66, v67
  v_mfma_f32_32x32x16_bf16 v[48:63], v[32:35], v[96:99], 0
  v_exp_f32 v68, v68
  v_exp_f32 v69, v69
  v_exp_f32 v70, v70
  v_mfma_f32_32x32x8_bf16 v[48:63], v[44:45], v[120:121], v[48:63]
  v_exp_f32 v71, v71
  v_cvt_pk_bf16_f32 v66, v68, v69
  v_cvt_pk_bf16_f32 v67, v70, v71
  v_exp_f32 v72, v72
  v_exp_f32 v73, v73
  v_mfma_f32_32x32x16_bf16 v[176:191], v[36:39], v[64:67], v[176:191]
  v_exp_f32 v74, v74
  v_exp_f32 v75, v75
  v_cvt_pk_bf16_f32 v68, v72, v73
  v_cvt_pk_bf16_f32 v69, v74, v75
  v_exp_f32 v76, v76
  v_exp_f32 v77, v77
  v_exp_f32 v78, v78
  v_exp_f32 v79, v79
  v_cvt_pk_bf16_f32 v70, v76, v77
  v_cvt_pk_bf16_f32 v71, v78, v79
  v_exp_f32 v48, v48
  v_exp_f32 v49, v49
  v_mfma_f32_32x32x16_bf16 v[176:191], v[40:43], v[68:71], v[176:191]
  v_exp_f32 v50, v50
  v_exp_f32 v51, v51
  v_cvt_pk_bf16_f32 v48, v48, v49
  v_cvt_pk_bf16_f32 v49, v50, v51
  v_mfma_f32_32x32x16_bf16 v[64:79], v[32:35], v[100:103], 0
  v_exp_f32 v52, v52
  v_exp_f32 v53, v53
  v_exp_f32 v54, v54
  v_mfma_f32_32x32x8_bf16 v[64:79], v[44:45], v[122:123], v[64:79]
  v_exp_f32 v55, v55
  v_cvt_pk_bf16_f32 v50, v52, v53
  v_cvt_pk_bf16_f32 v51, v54, v55
  v_exp_f32 v56, v56
  v_exp_f32 v57, v57
  v_mfma_f32_32x32x16_bf16 v[192:207], v[36:39], v[48:51], v[192:207]
  v_exp_f32 v58, v58
  v_exp_f32 v59, v59
  v_cvt_pk_bf16_f32 v52, v56, v57
  v_cvt_pk_bf16_f32 v53, v58, v59
  v_exp_f32 v60, v60
  v_exp_f32 v61, v61
  v_exp_f32 v62, v62
  v_exp_f32 v63, v63
  v_cvt_pk_bf16_f32 v54, v60, v61
  v_cvt_pk_bf16_f32 v55, v62, v63
  v_exp_f32 v64, v64
  v_exp_f32 v65, v65
  v_mfma_f32_32x32x16_bf16 v[192:207], v[40:43], v[52:55], v[192:207]
  v_exp_f32 v66, v66
  v_exp_f32 v67, v67
  v_cvt_pk_bf16_f32 v64, v64, v65
  v_cvt_pk_bf16_f32 v65, v66, v67
  v_mfma_f32_32x32x16_bf16 v[48:63], v[32:35], v[104:107], 0
  v_exp_f32 v68, v68
  v_exp_f32 v69, v69
  v_exp_f32 v70, v70
  v_mfma_f32_32x32x8_bf16 v[48:63], v[44:45], v[124:125], v[48:63]
  v_exp_f32 v71, v71
  v_cvt_pk_bf16_f32 v66, v68, v69
  v_cvt_pk_bf16_f32 v67, v70, v71
  v_exp_f32 v72, v72
  v_exp_f32 v73, v73
  v_mfma_f32_32x32x16_bf16 v[208:223], v[36:39], v[64:67], v[208:223]
  v_exp_f32 v74, v74
  v_exp_f32 v75, v75
  v_cvt_pk_bf16_f32 v68, v72, v73
  v_cvt_pk_bf16_f32 v69, v74, v75
  v_exp_f32 v76, v76
  v_exp_f32 v77, v77
  v_exp_f32 v78, v78
  v_exp_f32 v79, v79
  v_cvt_pk_bf16_f32 v70, v76, v77
  v_cvt_pk_bf16_f32 v71, v78, v79
  v_exp_f32 v48, v48
  v_exp_f32 v49, v49
  v_mfma_f32_32x32x16_bf16 v[208:223], v[40:43], v[68:71], v[208:223]
  v_exp_f32 v50, v50
  v_exp_f32 v51, v51
  v_cvt_pk_bf16_f32 v48, v48, v49
  v_cvt_pk_bf16_f32 v49, v50, v51
  v_mfma_f32_32x32x16_bf16 v[64:79], v[32:35], v[108:111], 0
  v_exp_f32 v52, v52
  v_exp_f32 v53, v53
  v_exp_f32 v54, v54
  v_mfma_f32_32x32x8_bf16 v[64:79], v[44:45], v[126:127], v[64:79]
  v_exp_f32 v55, v55
  v_cvt_pk_bf16_f32 v50, v52, v53
  v_cvt_pk_bf16_f32 v51, v54, v55
  v_exp_f32 v56, v56
  v_exp_f32 v57, v57
  v_mfma_f32_32x32x16_bf16 v[224:239], v[36:39], v[48:51], v[224:239]
  v_exp_f32 v58, v58
  v_exp_f32 v59, v59
  v_cvt_pk_bf16_f32 v52, v56, v57
  v_cvt_pk_bf16_f32 v53, v58, v59
  v_exp_f32 v60, v60
  v_exp_f32 v61, v61
  v_exp_f32 v62, v62
  v_exp_f32 v63, v63
  v_cvt_pk_bf16_f32 v54, v60, v61
  v_cvt_pk_bf16_f32 v55, v62, v63
  v_exp_f32 v64, v64
  v_exp_f32 v65, v65
  v_mfma_f32_32x32x16_bf16 v[224:239], v[40:43], v[52:55], v[224:239]
  v_exp_f32 v66, v66
  v_exp_f32 v67, v67
  v_cvt_pk_bf16_f32 v64, v64, v65
  v_cvt_pk_bf16_f32 v65, v66, v67
  s_waitcnt vmcnt(0)
  v_mfma_f32_32x32x16_bf16 v[48:63], v[16:19], v[80:83], 0
  v_exp_f32 v68, v68
  v_exp_f32 v69, v69
  v_exp_f32 v70, v70
  v_mfma_f32_32x32x8_bf16 v[48:63], v[28:29], v[112:113], v[48:63]
  v_exp_f32 v71, v71
  v_cvt_pk_bf16_f32 v66, v68, v69
  v_cvt_pk_bf16_f32 v67, v70, v71
  v_exp_f32 v72, v72
  v_exp_f32 v73, v73
  v_mfma_f32_32x32x16_bf16 v[240:255], v[36:39], v[64:67], v[240:255]
  v_exp_f32 v74, v74
  v_exp_f32 v75, v75
  v_cvt_pk_bf16_f32 v68, v72, v73
  v_cvt_pk_bf16_f32 v69, v74, v75
  v_exp_f32 v76, v76
  v_exp_f32 v77, v77
  v_exp_f32 v78, v78
  v_exp_f32 v79, v79
  v_cvt_pk_bf16_f32 v70, v76, v77
  v_cvt_pk_bf16_f32 v71, v78, v79
  s_sub_u32 s8, s8, 1
  s_branch att_loop
att_last:
  v_mov_b32 v4, 162848
  s_mov_b32 s9, 0x40000
lw_15:
  ds_read_b32 v5, v4
  s_waitcnt lgkmcnt(0)
  v_readfirstlane_b32 s8, v5
  s_cmp_ge_u32 s8, 4
  s_cbranch_scc1 lwd_16
  s_sleep 1
  s_sub_u32 s9, s9, 1
  s_cmp_lg_u32 s9, 0
  s_cbranch_scc1 lw_15
lwd_16:
  v_exp_f32 v48, v48
  v_exp_f32 v49, v49
  v_mfma_f32_32x32x16_bf16 v[240:255], v[24:27], v[68:71], v[240:255]
  v_exp_f32 v50, v50
  v_exp_f32 v51, v51
  v_cvt_pk_bf16_f32 v48, v48, v49
  v_cvt_pk_bf16_f32 v49, v50, v51
  v_mfma_f32_32x32x16_bf16 v[64:79], v[32:35], v[84:87], 0
  v_exp_f32 v52, v52
  v_exp_f32 v53, v53
  v_exp_f32 v54, v54
  v_mfma_f32_32x32x8_bf16 v[64:79], v[44:45], v[114:115], v[64:79]
  v_exp_f32 v55, v55
  v_cvt_pk_bf16_f32 v50, v52, v53
  v_cvt_pk_bf16_f32 v51, v54, v55
  v_exp_f32 v56, v56
  v_exp_f32 v57, v57
  v_mfma_f32_32x32x16_bf16 v[128:143], v[36:39], v[48:51], v[128:143]
  v_exp_f32 v58, v58
  v_exp_f32 v59, v59
  v_cvt_pk_bf16_f32 v52, v56, v57
  v_cvt_pk_bf16_f32 v53, v58, v59
  v_exp_f32 v60, v60
  v_exp_f32 v61, v61
  v_exp_f32 v62, v62
  v_exp_f32 v63, v63
  v_cvt_pk_bf16_f32 v54, v60, v61
  v_cvt_pk_bf16_f32 v55, v62, v63
  v_exp_f32 v64, v64
  v_exp_f32 v65, v65
  v_mfma_f32_32x32x16_bf16 v[128:143], v[40:43], v[52:55], v[128:143]
  v_exp_f32 v66, v66
  v_exp_f32 v67, v67
  v_cvt_pk_bf16_f32 v64, v64, v65
  v_cvt_pk_bf16_f32 v65, v66, v67
  v_mfma_f32_32x32x16_bf16 v[48:63], v[32:35], v[88:91], 0
  v_exp_f32 v68, v68
  v_exp_f32 v69, v69
  v_exp_f32 v70, v70
  v_mfma_f32_32x32x8_bf16 v[48:63], v[44:45], v[116:117], v[48:63]
  v_exp_f32 v71, v71
  v_cvt_pk_bf16_f32 v66, v68, v69
  v_cvt_pk_bf16_f32 v67, v70, v71
  v_exp_f32 v72, v72
  v_exp_f32 v73, v73
  v_mfma_f32_32x32x16_bf16 v[144:159], v[36:39], v[64:67], v[144:159]
  v_exp_f32 v74, v74
  v_exp_f32 v75, v75
  ds_write_b128 v15, v[128:131] offset:0
  v_cvt_pk_bf16_f32 v68, v72, v73
  v_cvt_pk_bf16_f32 v69, v74, v75
  v_exp_f32 v76, v76
  ds_write_b128 v15, v[132:135] offset:1024
  v_exp_f32 v77, v77
  v_exp_f32 v78, v78
  v_exp_f32 v79, v79
  ds_write_b128 v15, v[136:139] offset:2048
  v_cvt_pk_bf16_f32 v70, v76, v77
  v_cvt_pk_bf16_f32 v71, v78, v79
  v_exp_f32 v48, v48
  v_exp_f32 v49, v49
  v_mfma_f32_32x32x16_bf16 v[144:159], v[40:43], v[68:71], v[144:159]
  v_exp_f32 v50, v50
  v_exp_f32 v51, v51
  v_cvt_pk_bf16_f32 v48, v48, v49
  v_cvt_pk_bf16_f32 v49, v50, v51
  v_mfma_f32_32x32x16_bf16 v[64:79], v[32:35], v[92:95], 0
  v_exp_f32 v52, v52
  v_exp_f32 v53, v53
  v_exp_f32 v54, v54
  v_mfma_f32_32x32x8_bf16 v[64:79], v[44:45], v[118:119], v[64:79]
  v_exp_f32 v55, v55
  v_cvt_pk_bf16_f32 v50, v52, v53
  v_cvt_pk_bf16_f32 v51, v54, v55
  v_exp_f32 v56, v56
  v_exp_f32 v57, v57
  v_mfma_f32_32x32x16_bf16 v[160:175], v[36:39], v[48:51], v[160:175]
  v_exp_f32 v58, v58
  v_exp_f32 v59, v59
  ds_write_b128 v15, v[144:147] offset:3072
  v_cvt_pk_bf16_f32 v52, v56, v57
  v_cvt_pk_bf16_f32 v53, v58, v59
  v_exp_f32 v60, v60
  ds_write_b128 v15, v[148:151] offset:4096
  v_exp_f32 v61, v61
  v_exp_f32 v62, v62
  v_exp_f32 v63, v63
  ds_write_b128 v15, v[152:155] offset:5120
  v_cvt_pk_bf16_f32 v54, v60, v61
  v_cvt_pk_bf16_f32 v55, v62, v63
  v_exp_f32 v64, v64
  v_exp_f32 v65, v65
  v_mfma_f32_32x32x16_bf16 v[160:175], v[40:43], v[52:55], v[160:175]
  v_exp_f32 v66, v66
  v_exp_f32 v67, v67
  v_cvt_pk_bf16_f32 v64, v64, v65
  v_cvt_pk_bf16_f32 v65, v66, v67
  v_mfma_f32_32x32x16_bf16 v[48:63], v[32:35], v[96:99], 0
  v_exp_f32 v68, v68
  v_exp_f32 v69, v69
  v_exp_f32 v70, v70
  v_mfma_f32_32x32x8_bf16 v[48:63], v[44:45], v[120:121], v[48:63]
  v_exp_f32 v71, v71
  v_cvt_pk_bf16_f32 v66, v68, v69
  v_cvt_pk_bf16_f32 v67, v70, v71
  v_exp_f32 v72, v72
  v_exp_f32 v73, v73
  v_mfma_f32_32x32x16_bf16 v[176:191], v[36:39], v[64:67], v[176:191]
  v_exp_f32 v74, v74
  v_exp_f32 v75, v75
  ds_write_b128 v15, v[160:163] offset:6144
  v_cvt_pk_bf16_f32 v68, v72, v73
  v_cvt_pk_bf16_f32 v69, v74, v75
  v_exp_f32 v76, v76
  ds_write_b128 v15, v[164:167] offset:7168
  v_exp_f32 v77, v77
  v_exp_f32 v78, v78
  v_exp_f32 v79, v79
  ds_write_b128 v15, v[168:171] offset:8192
  v_cvt_pk_bf16_f32 v70, v76, v77
  v_cvt_pk_bf16_f32 v71, v78, v79
  v_exp_f32 v48, v48
  v_exp_f32 v49, v49
  v_mfma_f32_32x32x16_bf16 v[176:191], v[40:43], v[68:71], v[176:191]
  v_exp_f32 v50, v50
  v_exp_f32 v51, v51
  v_cvt_pk_bf16_f32 v48, v48, v49
  v_cvt_pk_bf16_f32 v49, v50, v51
  v_mfma_f32_32x32x16_bf16 v[64:79], v[32:35], v[100:103], 0
  v_exp_f32 v52, v52
  v_exp_f32 v53, v53
  v_exp_f32 v54, v54
  v_mfma_f32_32x32x8_bf16 v[64:79], v[44:45], v[122:123], v[64:79]
  v_exp_f32 v55, v55
  v_cvt_pk_bf16_f32 v50, v52, v53
  v_cvt_pk_bf16_f32 v51, v54, v55
  v_exp_f32 v56, v56
  v_exp_f32 v57, v57
  v_mfma_f32_32x32x16_bf16 v[192:207], v[36:39], v[48:51], v[192:207]
  v_exp_f32 v58, v58
  v_exp_f32 v59, v59
  ds_write_b128 v15, v[176:179] offset:9216
  v_cvt_pk_bf16_f32 v52, v56, v57
  v_cvt_pk_bf16_f32 v53, v58, v59
  v_exp_f32 v60, v60
  ds_write_b128 v15, v[180:183] offset:10240
  v_exp_f32 v61, v61
  v_exp_f32 v62, v62
  v_exp_f32 v63, v63
  ds_write_b128 v15, v[184:187] offset:11264
  v_cvt_pk_bf16_f32 v54, v60, v61
  v_cvt_pk_bf16_f32 v55, v62, v63
  v_exp_f32 v64, v64
  v_exp_f32 v65, v65
  v_mfma_f32_32x32x16_bf16 v[192:207], v[40:43], v[52:55], v[192:207]
  v_exp_f32 v66, v66
  v_exp_f32 v67, v67
  v_cvt_pk_bf16_f32 v64, v64, v65
  v_cvt_pk_bf16_f32 v65, v66, v67
  v_mfma_f32_32x32x16_bf16 v[48:63], v[32:35], v[104:107], 0
  v_exp_f32 v68, v68
  v_exp_f32 v69, v69
  v_exp_f32 v70, v70
  v_mfma_f32_32x32x8_bf16 v[48:63], v[44:45], v[124:125], v[48:63]
  v_exp_f32 v71, v71
  v_cvt_pk_bf16_f32 v66, v68, v69
  v_cvt_pk_bf16_f32 v67, v70, v71
  v_exp_f32 v72, v72
  v_exp_f32 v73, v73
  v_mfma_f32_32x32x16_bf16 v[208:223], v[36:39], v[64:67], v[208:223]
  v_exp_f32 v74, v74
  v_exp_f32 v75, v75
  ds_write_b128 v15, v[192:195] offset:12288
  v_cvt_pk_bf16_f32 v68, v72, v73
  v_cvt_pk_bf16_f32 v69, v74, v75
  v_exp_f32 v76, v76
  ds_write_b128 v15, v[196:199] offset:13312
  v_exp_f32 v77, v77
  v_exp_f32 v78, v78
  v_exp_f32 v79, v79
  ds_write_b128 v15, v[200:203] offset:14336
  v_cvt_pk_bf16_f32 v70, v76, v77
  v_cvt_pk_bf16_f32 v71, v78, v79
  v_exp_f32 v48, v48
  v_exp_f32 v49, v49
  v_mfma_f32_32x32x16_bf16 v[208:223], v[40:43], v[68:71], v[208:223]
  v_exp_f32 v50, v50
  v_exp_f32 v51, v51
  v_cvt_pk_bf16_f32 v48, v48, v49
  v_cvt_pk_bf16_f32 v49, v50, v51
  v_mfma_f32_32x32x16_bf16 v[64:79], v[32:35], v[108:111], 0
  v_exp_f32 v52, v52
  v_exp_f32 v53, v53
  v_exp_f32 v54, v54
  v_mfma_f32_32x32x8_bf16 v[64:79], v[44:45], v[126:127], v[64:79]
  v_exp_f32 v55, v55
  v_cvt_pk_bf16_f32 v50, v52, v53
  v_cvt_pk_bf16_f32 v51, v54, v55
  v_exp_f32 v56, v56
  v_exp_f32 v57, v57
  v_mfma_f32_32x32x16_bf16 v[224:239], v[36:39], v[48:51], v[224:239]
  v_exp_f32 v58, v58
  v_exp_f32 v59, v59
  ds_write_b128 v15, v[208:211] offset:15360
  v_cvt_pk_bf16_f32 v52, v56, v57
  v_cvt_pk_bf16_f32 v53, v58, v59
  v_exp_f32 v60, v60
  ds_write_b128 v15, v[212:215] offset:16384
  v_exp_f32 v61, v61
  v_exp_f32 v62, v62
  v_exp_f32 v63, v63
  ds_write_b128 v15, v[216:219] offset:17408
  v_cvt_pk_bf16_f32 v54, v60, v61
  v_cvt_pk_bf16_f32 v55, v62, v63
  v_exp_f32 v64, v64
  v_exp_f32 v65, v65
  v_mfma_f32_32x32x16_bf16 v[224:239], v[40:43], v[52:55], v[224:239]
  v_exp_f32 v66, v66
  v_exp_f32 v67, v67
  v_cvt_pk_bf16_f32 v64, v64, v65
  v_cvt_pk_bf16_f32 v65, v66, v67
  v_exp_f32 v68, v68
  v_exp_f32 v69, v69
  v_exp_f32 v70, v70
  v_exp_f32 v71, v71
  v_cvt_pk_bf16_f32 v66, v68, v69
  v_cvt_pk_bf16_f32 v67, v70, v71
  v_exp_f32 v72, v72
  v_exp_f32 v73, v73
  v_mfma_f32_32x32x16_bf16 v[240:255], v[36:39], v[64:67], v[240:255]
  v_exp_f32 v74, v74
  v_exp_f32 v75, v75
  v_cvt_pk_bf16_f32 v68, v72, v73
  v_cvt_pk_bf16_f32 v69, v74, v75
  v_exp_f32 v76, v76
  v_exp_f32 v77, v77
  v_exp_f32 v78, v78
  v_exp_f32 v79, v79
  v_cvt_pk_bf16_f32 v70, v76, v77
  v_cvt_pk_bf16_f32 v71, v78, v79
  s_setprio 3
  s_nop 0
  v_mfma_f32_32x32x16_bf16 v[240:255], v[40:43], v[68:71], v[240:255]
  s_waitcnt lgkmcnt(0)
  v_mov_b32 v6, 162820
  v_mov_b32 v7, 1
  s_mov_b64 exec, 1
  ds_add_u32 v6, v7
  s_mov_b64 exec, -1
  s_mul_i32 s10, s4, 40
  s_mul_i32 s11, s5, 5
  s_add_u32 s10, s10, s11
  s_add_u32 s11, s10, 4
  s_add_u32 s10, s10, s3
  s_lshl_b32 s10, s10, 11
  s_add_u32 s10, s10, 8388608
  s_lshl_b32 s11, s11, 11
  s_add_u32 s11, s11, 8388608
  s_lshl_b32 s12, s3, 9
  v_add_u32 v10, s12, v2
  v_mov_b32 v11, 2130706432
  v_cmp_gt_u32 vcc, 32, v0
  s_sub_u32 s9, s3, 1
  s_and_b32 s9, s9, 3
  s_mul_i32 s9, s9, 18432
  v_add_u32 v12, s9, v2
  s_sub_u32 s9, s3, 2
  s_and_b32 s9, s9, 3
  s_mul_i32 s9, s9, 18432
  v_add_u32 v13, s9, v2
  s_sub_u32 s9, s3, 3
  s_and_b32 s9, s9, 3
  s_mul_i32 s9, s9, 18432
  v_add_u32 v14, s9, v2
  v_cndmask_b32 v10, v11, v10, vcc
  s_cmp_lg_u32 s79, 0
  s_cbranch_scc1 att_done
  s_mov_b32 s81, 0x17800000
  s_mov_b32 s82, 0x5d800000
  s_mov_b64 s[76:77], 0
  v_mov_b32 v4, 162820
  s_mov_b32 s9, 0x40000
lw_17:
  ds_read_b32 v5, v4
  s_waitcnt lgkmcnt(0)
  v_readfirstlane_b32 s8, v5
  s_cmp_ge_u32 s8, s80
  s_cbranch_scc1 lwd_18
  s_sub_u32 s9, s9, 1
  s_cmp_lg_u32 s9, 0
  s_cbranch_scc1 lw_17
lwd_18:
  ds_read_b128 v[128:131], v12 offset:0
  ds_read_b128 v[132:135], v12 offset:1024
  ds_read_b128 v[136:139], v12 offset:2048
  ds_read_b128 v[140:143], v13 offset:6144
  ds_read_b128 v[144:147], v13 offset:7168
  ds_read_b128 v[148:151], v13 offset:8192
  ds_read_b128 v[152:155], v14 offset:12288
  ds_read_b128 v[156:159], v14 offset:13312
  ds_read_b128 v[160:163], v14 offset:14336
  ds_read_b128 v[164:167], v12 offset:3072
  ds_read_b128 v[168:171], v12 offset:4096
  ds_read_b128 v[172:175], v12 offset:5120
  ds_read_b128 v[176:179], v13 offset:9216
  ds_read_b128 v[180:183], v13 offset:10240
  ds_read_b128 v[184:187], v13 offset:11264
  ds_read_b128 v[188:191], v14 offset:15360
  ds_read_b128 v[192:195], v14 offset:16384
  ds_read_b128 v[196:199], v14 offset:17408
  s_waitcnt lgkmcnt(9)
  v_pk_add_f32 v[232:233], v[232:233], v[136:137]
  v_pk_add_f32 v[148:149], v[148:149], v[160:161]
  v_pk_add_f32 v[224:225], v[224:225], v[128:129]
  v_pk_add_f32 v[140:141], v[140:141], v[152:153]
  v_pk_add_f32 v[226:227], v[226:227], v[130:131]
  v_pk_add_f32 v[142:143], v[142:143], v[154:155]
  v_pk_add_f32 v[228:229], v[228:229], v[132:133]
  v_pk_add_f32 v[144:145], v[144:145], v[156:157]
  v_pk_add_f32 v[230:231], v[230:231], v[134:135]
  v_pk_add_f32 v[146:147], v[146:147], v[158:159]
  v_pk_add_f32 v[234:235], v[234:235], v[138:139]
  v_pk_add_f32 v[150:151], v[150:151], v[162:163]
  v_pk_add_f32 v[232:233], v[232:233], v[148:149]
  v_pk_add_f32 v[224:225], v[224:225], v[140:141]
  v_pk_add_f32 v[226:227], v[226:227], v[142:143]
  v_pk_add_f32 v[228:229], v[228:229], v[144:145]
  v_pk_add_f32 v[230:231], v[230:231], v[146:147]
  v_pk_add_f32 v[234:235], v[234:235], v[150:151]
  v_mov_b32 v8, v232
  v_mov_b32 v9, v232
  s_nop 1
  v_permlane32_swap_b32 v8, v9
  s_nop 1
  v_rcp_f32 v8, v9
  v_cmp_nle_f32 vcc, s81, v9
  s_or_b64 s[76:77], s[76:77], vcc
  v_cmp_nge_f32 vcc, s82, v9
  s_or_b64 s[76:77], s[76:77], vcc
  v_pk_mul_f32 v[224:225], v[224:225], v[8:9] op_sel_hi:[1,0]
  v_pk_mul_f32 v[226:227], v[226:227], v[8:9] op_sel_hi:[1,0]
  v_pk_mul_f32 v[228:229], v[228:229], v[8:9] op_sel_hi:[1,0]
  v_pk_mul_f32 v[230:231], v[230:231], v[8:9] op_sel_hi:[1,0]
  v_pk_mul_f32 v[232:233], v[232:233], v[8:9] op_sel_hi:[1,0]
  v_pk_mul_f32 v[234:235], v[234:235], v[8:9] op_sel_hi:[1,0]
  v_cvt_pk_bf16_f32 v128, v224, v225
  v_cvt_pk_bf16_f32 v129, v226, v227
  v_cvt_pk_bf16_f32 v130, v228, v229
  v_cvt_pk_bf16_f32 v131, v230, v231
  buffer_store_dwordx4 v[128:131], v2, s[72:75], s10 offen offset:0 sc1
  v_cvt_pk_bf16_f32 v200, v232, v233
  v_cvt_pk_bf16_f32 v201, v234, v235
  s_waitcnt lgkmcnt(0)
  v_pk_add_f32 v[248:249], v[248:249], v[172:173]
  v_pk_add_f32 v[184:185], v[184:185], v[196:197]
  v_pk_add_f32 v[240:241], v[240:241], v[164:165]
  v_pk_add_f32 v[176:177], v[176:177], v[188:189]
  v_pk_add_f32 v[242:243], v[242:243], v[166:167]
  v_pk_add_f32 v[178:179], v[178:179], v[190:191]
  v_pk_add_f32 v[244:245], v[244:245], v[168:169]
  v_pk_add_f32 v[180:181], v[180:181], v[192:193]
  v_pk_add_f32 v[246:247], v[246:247], v[170:171]
  v_pk_add_f32 v[182:183], v[182:183], v[194:195]
  v_pk_add_f32 v[250:251], v[250:251], v[174:175]
  v_pk_add_f32 v[186:187], v[186:187], v[198:199]
  v_pk_add_f32 v[248:249], v[248:249], v[184:185]
  v_pk_add_f32 v[240:241], v[240:241], v[176:177]
  v_pk_add_f32 v[242:243], v[242:243], v[178:179]
  v_pk_add_f32 v[244:245], v[244:245], v[180:181]
  v_pk_add_f32 v[246:247], v[246:247], v[182:183]
  v_pk_add_f32 v[250:251], v[250:251], v[186:187]
  v_mov_b32 v8, v248
  v_mov_b32 v9, v248
  s_nop 1
  v_permlane32_swap_b32 v8, v9
  s_nop 1
  v_rcp_f32 v8, v9
  v_cmp_nle_f32 vcc, s81, v9
  s_or_b64 s[76:77], s[76:77], vcc
  v_cmp_nge_f32 vcc, s82, v9
  s_or_b64 s[76:77], s[76:77], vcc
  v_pk_mul_f32 v[240:241], v[240:241], v[8:9] op_sel_hi:[1,0]
  v_pk_mul_f32 v[242:243], v[242:243], v[8:9] op_sel_hi:[1,0]
  v_pk_mul_f32 v[244:245], v[244:245], v[8:9] op_sel_hi:[1,0]
  v_pk_mul_f32 v[246:247], v[246:247], v[8:9] op_sel_hi:[1,0]
  v_pk_mul_f32 v[248:249], v[248:249], v[8:9] op_sel_hi:[1,0]
  v_pk_mul_f32 v[250:251], v[250:251], v[8:9] op_sel_hi:[1,0]
  v_cvt_pk_bf16_f32 v164, v240, v241
  v_cvt_pk_bf16_f32 v165, v242, v243
  v_cvt_pk_bf16_f32 v166, v244, v245
  v_cvt_pk_bf16_f32 v167, v246, v247
  buffer_store_dwordx4 v[164:167], v2, s[72:75], s10 offen offset:1024 sc1
  v_cvt_pk_bf16_f32 v202, v248, v249
  v_cvt_pk_bf16_f32 v203, v250, v251
  buffer_store_dwordx4 v[200:203], v10, s[72:75], s11 offen sc1
  s_lshl_b32 s12, s4, 15
  s_and_b32 s13, s5, 3
  s_lshl_b32 s13, s13, 10
  s_add_u32 s12, s12, s13
  s_and_b32 s13, s5, 4
  s_add_u32 s13, s13, s3
  s_lshl_b32 s13, s13, 7
  s_add_u32 s12, s12, s13
  s_add_u32 s12, s12, 16777216
  v_lshlrev_b32 v8, 12, v0
  s_cmp_lg_u32 s78, 0
  s_cbranch_scc1 att_pub
  s_cmp_eq_u64 s[76:77], 0
  s_cbranch_scc1 att_pub
  s_waitcnt lgkmcnt(0)
  v_mov_b32 v4, 162836
  v_mov_b32 v5, 1
  s_mov_b64 exec, 1
  ds_add_u32 v4, v5
  s_mov_b64 exec, -1
  s_branch att_nopub
att_pub:
  v_mov_b32 v9, s15
  s_waitcnt vmcnt(0)
  s_mov_b64 exec, 0xff
  buffer_store_dword v9, v8, s[72:75], s12 offen sc1
  s_mov_b64 exec, -1
  s_mov_b32 s79, 1
att_nopub:
  s_cmp_lg_u32 s78, 0
  s_cbranch_scc1 att_done
  s_waitcnt lgkmcnt(0)
  v_mov_b32 v4, 162832
  v_mov_b32 v5, 1
  s_mov_b64 exec, 1
  ds_add_u32 v4, v5
  s_mov_b64 exec, -1
  v_mov_b32 v4, 162832
  s_mov_b32 s9, 0x40000
lw_19:
  ds_read_b32 v5, v4
  s_waitcnt lgkmcnt(0)
  v_readfirstlane_b32 s8, v5
  s_cmp_ge_u32 s8, 4
  s_cbranch_scc1 lwd_20
  s_sleep 1
  s_sub_u32 s9, s9, 1
  s_cmp_lg_u32 s9, 0
  s_cbranch_scc1 lw_19
lwd_20:
  v_mov_b32 v4, 162836
  ds_read_b32 v5, v4
  s_waitcnt lgkmcnt(0)
  v_readfirstlane_b32 s8, v5
  s_cmp_eq_u32 s8, 0
  s_cbranch_scc1 att_done
  s_waitcnt vmcnt(0)
  v_mov_b32 v32, 0xff800000
  v_mov_b32 v33, 0xff800000
  v_mov_b32 v34, 0xff800000
  v_mov_b32 v35, 0xff800000
  v_mov_b32 v36, 0xff800000
  v_mov_b32 v37, 0xff800000
  v_mov_b32 v38, 0xff800000
  v_mov_b32 v39, 0xff800000
  s_mul_i32 s7, s3, 57344
  s_add_u32 s7, s7, 65536
  s_mov_b32 s8, 16
mx_loop:
  buffer_load_dwordx4 v[16:19], v2, s[48:51], s7 offen sc1
  buffer_load_dwordx2 v[28:29], v3, s[48:51], s7 offen offset:3072 sc1
  buffer_load_dwordx4 v[20:23], v2, s[48:51], s7 offen offset:1024 sc1
  buffer_load_dwordx4 v[24:27], v2, s[48:51], s7 offen offset:2048 sc1
  s_add_u32 s7, s7, 3584
  s_waitcnt vmcnt(0)
  v_mfma_f32_32x32x16_bf16 v[48:63], v[16:19], v[80:83], 0
  v_mfma_f32_32x32x8_bf16 v[48:63], v[28:29], v[112:113], v[48:63]
  s_nop 11
  v_max3_f32 v32, v32, v48, v49
  v_max3_f32 v32, v32, v50, v51
  v_max3_f32 v32, v32, v52, v53
  v_max3_f32 v32, v32, v54, v55
  v_max3_f32 v32, v32, v56, v57
  v_max3_f32 v32, v32, v58, v59
  v_max3_f32 v32, v32, v60, v61
  v_max3_f32 v32, v32, v62, v63
  v_mfma_f32_32x32x16_bf16 v[64:79], v[16:19], v[84:87], 0
  v_mfma_f32_32x32x8_bf16 v[64:79], v[28:29], v[114:115], v[64:79]
  s_nop 11
  v_max3_f32 v33, v33, v64, v65
  v_max3_f32 v33, v33, v66, v67
  v_max3_f32 v33, v33, v68, v69
  v_max3_f32 v33, v33, v70, v71
  v_max3_f32 v33, v33, v72, v73
  v_max3_f32 v33, v33, v74, v75
  v_max3_f32 v33, v33, v76, v77
  v_max3_f32 v33, v33, v78, v79
  v_mfma_f32_32x32x16_bf16 v[48:63], v[16:19], v[88:91], 0
  v_mfma_f32_32x32x8_bf16 v[48:63], v[28:29], v[116:117], v[48:63]
  s_nop 11
  v_max3_f32 v34, v34, v48, v49
  v_max3_f32 v34, v34, v50, v51
  v_max3_f32 v34, v34, v52, v53
  v_max3_f32 v34, v34, v54, v55
  v_max3_f32 v34, v34, v56, v57
  v_max3_f32 v34, v34, v58, v59
  v_max3_f32 v34, v34, v60, v61
  v_max3_f32 v34, v34, v62, v63
  v_mfma_f32_32x32x16_bf16 v[64:79], v[16:19], v[92:95], 0
  v_mfma_f32_32x32x8_bf16 v[64:79], v[28:29], v[118:119], v[64:79]
  s_nop 11
  v_max3_f32 v35, v35, v64, v65
  v_max3_f32 v35, v35, v66, v67
  v_max3_f32 v35, v35, v68, v69
  v_max3_f32 v35, v35, v70, v71
  v_max3_f32 v35, v35, v72, v73
  v_max3_f32 v35, v35, v74, v75
  v_max3_f32 v35, v35, v76, v77
  v_max3_f32 v35, v35, v78, v79
  v_mfma_f32_32x32x16_bf16 v[48:63], v[16:19], v[96:99], 0
  v_mfma_f32_32x32x8_bf16 v[48:63], v[28:29], v[120:121], v[48:63]
  s_nop 11
  v_max3_f32 v36, v36, v48, v49
  v_max3_f32 v36, v36, v50, v51
  v_max3_f32 v36, v36, v52, v53
  v_max3_f32 v36, v36, v54, v55
  v_max3_f32 v36, v36, v56, v57
  v_max3_f32 v36, v36, v58, v59
  v_max3_f32 v36, v36, v60, v61
  v_max3_f32 v36, v36, v62, v63
  v_mfma_f32_32x32x16_bf16 v[64:79], v[16:19], v[100:103], 0
  v_mfma_f32_32x32x8_bf16 v[64:79], v[28:29], v[122:123], v[64:79]
  s_nop 11
  v_max3_f32 v37, v37, v64, v65
  v_max3_f32 v37, v37, v66, v67
  v_max3_f32 v37, v37, v68, v69
  v_max3_f32 v37, v37, v70, v71
  v_max3_f32 v37, v37, v72, v73
  v_max3_f32 v37, v37, v74, v75
  v_max3_f32 v37, v37, v76, v77
  v_max3_f32 v37, v37, v78, v79
  v_mfma_f32_32x32x16_bf16 v[48:63], v[16:19], v[104:107], 0
  v_mfma_f32_32x32x8_bf16 v[48:63], v[28:29], v[124:125], v[48:63]
  s_nop 11
  v_max3_f32 v38, v38, v48, v49
  v_max3_f32 v38, v38, v50, v51
  v_max3_f32 v38, v38, v52, v53
  v_max3_f32 v38, v38, v54, v55
  v_max3_f32 v38, v38, v56, v57
  v_max3_f32 v38, v38, v58, v59
  v_max3_f32 v38, v38, v60, v61
  v_max3_f32 v38, v38, v62, v63
  v_mfma_f32_32x32x16_bf16 v[64:79], v[16:19], v[108:111], 0
  v_mfma_f32_32x32x8_bf16 v[64:79], v[28:29], v[126:127], v[64:79]
  s_nop 11
  v_max3_f32 v39, v39, v64, v65
  v_max3_f32 v39, v39, v66, v67
  v_max3_f32 v39, v39, v68, v69
  v_max3_f32 v39, v39, v70, v71
  v_max3_f32 v39, v39, v72, v73
  v_max3_f32 v39, v39, v74, v75
  v_max3_f32 v39, v39, v76, v77
  v_max3_f32 v39, v39, v78, v79
  s_sub_u32 s8, s8, 1
  s_cmp_lg_u32 s8, 0
  s_cbranch_scc1 mx_loop
  v_lshlrev_b32 v4, 2, v0
  s_add_u32 s9, s3, 1
  s_and_b32 s9, s9, 3
  s_lshl_b32 s9, s9, 9
  v_add_u32 v8, s9, v4
  s_add_u32 s9, s3, 2
  s_and_b32 s9, s9, 3
  s_lshl_b32 s9, s9, 9
  v_add_u32 v9, s9, v4
  s_add_u32 s9, s3, 3
  s_and_b32 s9, s9, 3
  s_lshl_b32 s9, s9, 9
  v_add_u32 v10, s9, v4
  s_add_u32 s9, s3, 4
  s_and_b32 s9, s9, 3
  s_lshl_b32 s9, s9, 9
  v_add_u32 v11, s9, v4
  s_lshl_b32 s9, s3, 11
  v_mov_b32 v5, v32
  s_nop 1
  v_permlane32_swap_b32 v5, v32
  s_nop 1
  v_max_f32 v32, v5, v32
  v_add_u32 v6, s9, v8
  ds_write_b32 v6, v32 offset:0
  v_mov_b32 v5, v33
  s_nop 1
  v_permlane32_swap_b32 v5, v33
  s_nop 1
  v_max_f32 v33, v5, v33
  v_add_u32 v6, s9, v8
  ds_write_b32 v6, v33 offset:256
  v_mov_b32 v5, v34
  s_nop 1
  v_permlane32_swap_b32 v5, v34
  s_nop 1
  v_max_f32 v34, v5, v34
  v_add_u32 v6, s9, v9
  ds_write_b32 v6, v34 offset:0
  v_mov_b32 v5, v35
  s_nop 1
  v_permlane32_swap_b32 v5, v35
  s_nop 1
  v_max_f32 v35, v5, v35
  v_add_u32 v6, s9, v9
  ds_write_b32 v6, v35 offset:256
  v_mov_b32 v5, v36
  s_nop 1
  v_permlane32_swap_b32 v5, v36
  s_nop 1
  v_max_f32 v36, v5, v36
  v_add_u32 v6, s9, v10
  ds_write_b32 v6, v36 offset:0
  v_mov_b32 v5, v37
  s_nop 1
  v_permlane32_swap_b32 v5, v37
  s_nop 1
  v_max_f32 v37, v5, v37
  v_add_u32 v6, s9, v10
  ds_write_b32 v6, v37 offset:256
  v_mov_b32 v5, v38
  s_nop 1
  v_permlane32_swap_b32 v5, v38
  s_nop 1
  v_max_f32 v38, v5, v38
  v_add_u32 v6, s9, v11
  ds_write_b32 v6, v38 offset:0
  v_mov_b32 v5, v39
  s_nop 1
  v_permlane32_swap_b32 v5, v39
  s_nop 1
  v_max_f32 v39, v5, v39
  v_add_u32 v6, s9, v11
  ds_write_b32 v6, v39 offset:256
  s_waitcnt lgkmcnt(0)
  v_mov_b32 v4, 162852
  v_mov_b32 v5, 1
  s_mov_b64 exec, 1
  ds_add_u32 v4, v5
  s_mov_b64 exec, -1
  v_mov_b32 v4, 162852
  s_mov_b32 s9, 0x40000
lw_21:
  ds_read_b32 v5, v4
  s_waitcnt lgkmcnt(0)
  v_readfirstlane_b32 s8, v5
  s_cmp_ge_u32 s8, 4
  s_cbranch_scc1 lwd_22
  s_sleep 1
  s_sub_u32 s9, s9, 1
  s_cmp_lg_u32 s9, 0
  s_cbranch_scc1 lw_21
lwd_22:
  s_mov_b32 s9, 0xffff0000
  v_cmp_lt_u32 vcc, 31, v0
  ds_read_b32 v48, v8 offset:0
  ds_read_b32 v49, v8 offset:2048
  ds_read_b32 v50, v8 offset:4096
  ds_read_b32 v51, v8 offset:6144
  s_waitcnt lgkmcnt(0)
  v_max3_f32 v4, v48, v49, v50
  v_max_f32 v4, v4, v51
  v_sub_f32 v4, 0, v4
  v_and_b32 v5, s9, v4
  v_sub_f32 v4, v4, v5
  v_and_b32 v6, s9, v4
  v_sub_f32 v4, v4, v6
  v_lshrrev_b32 v4, 16, v4
  v_lshrrev_b32 v5, 16, v5
  v_or_b32 v5, v5, v6
  v_cndmask_b32 v112, v112, v5, vcc
  v_cndmask_b32 v113, v113, v4, vcc
  ds_read_b32 v48, v8 offset:256
  ds_read_b32 v49, v8 offset:2304
  ds_read_b32 v50, v8 offset:4352
  ds_read_b32 v51, v8 offset:6400
  s_waitcnt lgkmcnt(0)
  v_max3_f32 v4, v48, v49, v50
  v_max_f32 v4, v4, v51
  v_sub_f32 v4, 0, v4
  v_and_b32 v5, s9, v4
  v_sub_f32 v4, v4, v5
  v_and_b32 v6, s9, v4
  v_sub_f32 v4, v4, v6
  v_lshrrev_b32 v4, 16, v4
  v_lshrrev_b32 v5, 16, v5
  v_or_b32 v5, v5, v6
  v_cndmask_b32 v114, v114, v5, vcc
  v_cndmask_b32 v115, v115, v4, vcc
  ds_read_b32 v48, v9 offset:0
  ds_read_b32 v49, v9 offset:2048
  ds_read_b32 v50, v9 offset:4096
  ds_read_b32 v51, v9 offset:6144
  s_waitcnt lgkmcnt(0)
  v_max3_f32 v4, v48, v49, v50
  v_max_f32 v4, v4, v51
  v_sub_f32 v4, 0, v4
  v_and_b32 v5, s9, v4
  v_sub_f32 v4, v4, v5
  v_and_b32 v6, s9, v4
  v_sub_f32 v4, v4, v6
  v_lshrrev_b32 v4, 16, v4
  v_lshrrev_b32 v5, 16, v5
  v_or_b32 v5, v5, v6
  v_cndmask_b32 v116, v116, v5, vcc
  v_cndmask_b32 v117, v117, v4, vcc
  ds_read_b32 v48, v9 offset:256
  ds_read_b32 v49, v9 offset:2304
  ds_read_b32 v50, v9 offset:4352
  ds_read_b32 v51, v9 offset:6400
  s_waitcnt lgkmcnt(0)
  v_max3_f32 v4, v48, v49, v50
  v_max_f32 v4, v4, v51
  v_sub_f32 v4, 0, v4
  v_and_b32 v5, s9, v4
  v_sub_f32 v4, v4, v5
  v_and_b32 v6, s9, v4
  v_sub_f32 v4, v4, v6
  v_lshrrev_b32 v4, 16, v4
  v_lshrrev_b32 v5, 16, v5
  v_or_b32 v5, v5, v6
  v_cndmask_b32 v118, v118, v5, vcc
  v_cndmask_b32 v119, v119, v4, vcc
  ds_read_b32 v48, v10 offset:0
  ds_read_b32 v49, v10 offset:2048
  ds_read_b32 v50, v10 offset:4096
  ds_read_b32 v51, v10 offset:6144
  s_waitcnt lgkmcnt(0)
  v_max3_f32 v4, v48, v49, v50
  v_max_f32 v4, v4, v51
  v_sub_f32 v4, 0, v4
  v_and_b32 v5, s9, v4
  v_sub_f32 v4, v4, v5
  v_and_b32 v6, s9, v4
  v_sub_f32 v4, v4, v6
  v_lshrrev_b32 v4, 16, v4
  v_lshrrev_b32 v5, 16, v5
  v_or_b32 v5, v5, v6
  v_cndmask_b32 v120, v120, v5, vcc
  v_cndmask_b32 v121, v121, v4, vcc
  ds_read_b32 v48, v10 offset:256
  ds_read_b32 v49, v10 offset:2304
  ds_read_b32 v50, v10 offset:4352
  ds_read_b32 v51, v10 offset:6400
  s_waitcnt lgkmcnt(0)
  v_max3_f32 v4, v48, v49, v50
  v_max_f32 v4, v4, v51
  v_sub_f32 v4, 0, v4
  v_and_b32 v5, s9, v4
  v_sub_f32 v4, v4, v5
  v_and_b32 v6, s9, v4
  v_sub_f32 v4, v4, v6
  v_lshrrev_b32 v4, 16, v4
  v_lshrrev_b32 v5, 16, v5
  v_or_b32 v5, v5, v6
  v_cndmask_b32 v122, v122, v5, vcc
  v_cndmask_b32 v123, v123, v4, vcc
  ds_read_b32 v48, v11 offset:0
  ds_read_b32 v49, v11 offset:2048
  ds_read_b32 v50, v11 offset:4096
  ds_read_b32 v51, v11 offset:6144
  s_waitcnt lgkmcnt(0)
  v_max3_f32 v4, v48, v49, v50
  v_max_f32 v4, v4, v51
  v_sub_f32 v4, 0, v4
  v_and_b32 v5, s9, v4
  v_sub_f32 v4, v4, v5
  v_and_b32 v6, s9, v4
  v_sub_f32 v4, v4, v6
  v_lshrrev_b32 v4, 16, v4
  v_lshrrev_b32 v5, 16, v5
  v_or_b32 v5, v5, v6
  v_cndmask_b32 v124, v124, v5, vcc
  v_cndmask_b32 v125, v125, v4, vcc
  ds_read_b32 v48, v11 offset:256
  ds_read_b32 v49, v11 offset:2304
  ds_read_b32 v50, v11 offset:4352
  ds_read_b32 v51, v11 offset:6400
  s_waitcnt lgkmcnt(0)
  v_max3_f32 v4, v48, v49, v50
  v_max_f32 v4, v4, v51
  v_sub_f32 v4, 0, v4
  v_and_b32 v5, s9, v4
  v_sub_f32 v4, v4, v5
  v_and_b32 v6, s9, v4
  v_sub_f32 v4, v4, v6
  v_lshrrev_b32 v4, 16, v4
  v_lshrrev_b32 v5, 16, v5
  v_or_b32 v5, v5, v6
  v_cndmask_b32 v126, v126, v5, vcc
  v_cndmask_b32 v127, v127, v4, vcc
  s_waitcnt lgkmcnt(0)
  v_mov_b32 v4, 162852
  v_mov_b32 v5, 1
  s_mov_b64 exec, 1
  ds_add_u32 v4, v5
  s_mov_b64 exec, -1
  v_mov_b32 v4, 162852
  s_mov_b32 s9, 0x40000
lw_23:
  ds_read_b32 v5, v4
  s_waitcnt lgkmcnt(0)
  v_readfirstlane_b32 s8, v5
  s_cmp_ge_u32 s8, 8
  s_cbranch_scc1 lwd_24
  s_sleep 1
  s_sub_u32 s9, s9, 1
  s_cmp_lg_u32 s9, 0
  s_cbranch_scc1 lw_23
lwd_24:
  v_mov_b32 v128, 0
  v_mov_b32 v129, 0
  v_mov_b32 v130, 0
  v_mov_b32 v131, 0
  v_mov_b32 v132, 0
  v_mov_b32 v133, 0
  v_mov_b32 v134, 0
  v_mov_b32 v135, 0
  v_mov_b32 v136, 0
  v_mov_b32 v137, 0
  v_mov_b32 v138, 0
  v_mov_b32 v139, 0
  v_mov_b32 v140, 0
  v_mov_b32 v141, 0
  v_mov_b32 v142, 0
  v_mov_b32 v143, 0
  v_mov_b32 v144, 0
  v_mov_b32 v145, 0
  v_mov_b32 v146, 0
  v_mov_b32 v147, 0
  v_mov_b32 v148, 0
  v_mov_b32 v149, 0
  v_mov_b32 v150, 0
  v_mov_b32 v151, 0
  v_mov_b32 v152, 0
  v_mov_b32 v153, 0
  v_mov_b32 v154, 0
  v_mov_b32 v155, 0
  v_mov_b32 v156, 0
  v_mov_b32 v157, 0
  v_mov_b32 v158, 0
  v_mov_b32 v159, 0
  v_mov_b32 v160, 0
  v_mov_b32 v161, 0
  v_mov_b32 v162, 0
  v_mov_b32 v163, 0
  v_mov_b32 v164, 0
  v_mov_b32 v165, 0
  v_mov_b32 v166, 0
  v_mov_b32 v167, 0
  v_mov_b32 v168, 0
  v_mov_b32 v169, 0
  v_mov_b32 v170, 0
  v_mov_b32 v171, 0
  v_mov_b32 v172, 0
  v_mov_b32 v173, 0
  v_mov_b32 v174, 0
  v_mov_b32 v175, 0
  v_mov_b32 v176, 0
  v_mov_b32 v177, 0
  v_mov_b32 v178, 0
  v_mov_b32 v179, 0
  v_mov_b32 v180, 0
  v_mov_b32 v181, 0
  v_mov_b32 v182, 0
  v_mov_b32 v183, 0
  v_mov_b32 v184, 0
  v_mov_b32 v185, 0
  v_mov_b32 v186, 0
  v_mov_b32 v187, 0
  v_mov_b32 v188, 0
  v_mov_b32 v189, 0
  v_mov_b32 v190, 0
  v_mov_b32 v191, 0
  v_mov_b32 v192, 0
  v_mov_b32 v193, 0
  v_mov_b32 v194, 0
  v_mov_b32 v195, 0
  v_mov_b32 v196, 0
  v_mov_b32 v197, 0
  v_mov_b32 v198, 0
  v_mov_b32 v199, 0
  v_mov_b32 v200, 0
  v_mov_b32 v201, 0
  v_mov_b32 v202, 0
  v_mov_b32 v203, 0
  v_mov_b32 v204, 0
  v_mov_b32 v205, 0
  v_mov_b32 v206, 0
  v_mov_b32 v207, 0
  v_mov_b32 v208, 0
  v_mov_b32 v209, 0
  v_mov_b32 v210, 0
  v_mov_b32 v211, 0
  v_mov_b32 v212, 0
  v_mov_b32 v213, 0
  v_mov_b32 v214, 0
  v_mov_b32 v215, 0
  v_mov_b32 v216, 0
  v_mov_b32 v217, 0
  v_mov_b32 v218, 0
  v_mov_b32 v219, 0
  v_mov_b32 v220, 0
  v_mov_b32 v221, 0
  v_mov_b32 v222, 0
  v_mov_b32 v223, 0
  v_mov_b32 v224, 0
  v_mov_b32 v225, 0
  v_mov_b32 v226, 0
  v_mov_b32 v227, 0
  v_mov_b32 v228, 0
  v_mov_b32 v229, 0
  v_mov_b32 v230, 0
  v_mov_b32 v231, 0
  v_mov_b32 v232, 0
  v_mov_b32 v233, 0
  v_mov_b32 v234, 0
  v_mov_b32 v235, 0
  v_mov_b32 v236, 0
  v_mov_b32 v237, 0
  v_mov_b32 v238, 0
  v_mov_b32 v239, 0
  v_mov_b32 v240, 0
  v_mov_b32 v241, 0
  v_mov_b32 v242, 0
  v_mov_b32 v243, 0
  v_mov_b32 v244, 0
  v_mov_b32 v245, 0
  v_mov_b32 v246, 0
  v_mov_b32 v247, 0
  v_mov_b32 v248, 0
  v_mov_b32 v249, 0
  v_mov_b32 v250, 0
  v_mov_b32 v251, 0
  v_mov_b32 v252, 0
  v_mov_b32 v253, 0
  v_mov_b32 v254, 0
  v_mov_b32 v255, 0
  v_mov_b32 v64, 0
  v_mov_b32 v65, 0
  v_mov_b32 v66, 0
  v_mov_b32 v67, 0
  v_mov_b32 v68, 0
  v_mov_b32 v69, 0
  v_mov_b32 v70, 0
  v_mov_b32 v71, 0
  v_mov_b32 v72, 0
  v_mov_b32 v73, 0
  v_mov_b32 v74, 0
  v_mov_b32 v75, 0
  v_mov_b32 v76, 0
  v_mov_b32 v77, 0
  v_mov_b32 v78, 0
  v_mov_b32 v79, 0
  v_mov_b32 v32, 0
  v_mov_b32 v33, 0
  v_mov_b32 v34, 0
  v_mov_b32 v35, 0
  v_mov_b32 v36, 0
  v_mov_b32 v37, 0
  v_mov_b32 v38, 0
  v_mov_b32 v39, 0
  v_mov_b32 v40, 0
  v_mov_b32 v41, 0
  v_mov_b32 v42, 0
  v_mov_b32 v43, 0
  v_mov_b32 v44, 0
  v_mov_b32 v45, 0
  v_mov_b32 v46, 0
  v_mov_b32 v47, 0
  s_mul_i32 s7, s3, 57344
  s_add_u32 s7, s7, 65536
  buffer_load_dwordx4 v[16:19], v2, s[48:51], s7 offen sc1
  buffer_load_dwordx2 v[28:29], v3, s[48:51], s7 offen offset:3072 sc1
  buffer_load_dwordx4 v[20:23], v2, s[48:51], s7 offen offset:1024 sc1
  buffer_load_dwordx4 v[24:27], v2, s[48:51], s7 offen offset:2048 sc1
  s_add_u32 s7, s7, 3584
  s_mov_b32 s78, 1
  s_mov_b32 s80, 8
  s_waitcnt vmcnt(0)
  s_branch att_start
att_done:
  s_or_b32 s12, s2, s3
  s_cmp_lg_u32 s12, 0
  s_cbranch_scc1 k_end
  v_mov_b32 v8, 0
  v_mov_b32 v9, s84
  s_mov_b64 exec, 1
  buffer_store_dword v9, v8, s[72:75], 0 offen sc1
  s_mov_b64 exec, -1
  s_branch k_end
pro_g:
  s_lshl_b32 s6, s9, 3
  s_add_u32 s6, s6, s5
  s_cmp_ge_u32 s6, 27
  s_cselect_b32 s78, 1280, 0
  s_cselect_b32 s79, 0, 3456
  s_add_u32 s78, s78, s79
  s_lshl_b32 s79, s78, 3
  s_lshl_b32 s80, s78, 4
  s_lshl_b32 s7, s6, 7
  s_mov_b32 s8, 0
  s_cmp_lt_u32 s6, 27
  s_cbranch_scc1 pro_gf
  s_mov_b32 s56, s44
  s_mov_b32 s60, s44
  s_mov_b32 s57, s45
  s_mov_b32 s61, s45
  s_mov_b32 s58, s46
  s_mov_b32 s62, s46
  s_sub_u32 s7, s6, 27
  s_lshl_b32 s7, s7, 8
  s_mov_b32 s8, 128
pro_gf:
  v_lshrrev_b32 v8, 3, v0
  v_mul_lo_u32 v9, v8, s78
  v_bfe_u32 v12, v0, 1, 2
  v_bfe_u32 v8, v0, 4, 1
  v_xor_b32 v12, v12, v8
  v_and_b32 v8, 1, v0
  v_lshl_add_u32 v9, v8, 4, v9
  v_add_u32 v9, s7, v9
  v_lshl_add_u32 v1, v12, 5, v9
  v_xor_b32 v12, 2, v12
  v_add_u32 v9, s8, v9
  v_lshl_add_u32 v15, v12, 5, v9
  s_mov_b32 s13, 0
  v_lshrrev_b32 v8, 5, v0
  v_or_b32 v56, 0, v8
  v_xor_b32 v56, v56, v0
  v_lshlrev_b32 v56, 4, v56
  v_or_b32 v57, 2, v8
  v_xor_b32 v57, v57, v0
  v_lshlrev_b32 v57, 4, v57
  v_or_b32 v58, 4, v8
  v_xor_b32 v58, v58, v0
  v_lshlrev_b32 v58, 4, v58
  v_or_b32 v59, 6, v8
  v_xor_b32 v59, v59, v0
  v_lshlrev_b32 v59, 4, v59
  v_lshrrev_b32 v12, 5, v0
  v_bfe_u32 v13, v0, 2, 2
  v_lshl_add_u32 v12, v12, 3, v13
  v_lshlrev_b32 v12, 7, v12
  v_bfe_u32 v13, v0, 1, 1
  v_lshl_add_u32 v12, v13, 11, v12
  v_and_b32 v14, 1, v0
  v_lshl_add_u32 v12, v14, 4, v12
  v_bfe_u32 v14, v0, 4, 1
  v_lshl_add_u32 v12, v14, 3, v12
  v_add_u32 v12, s10, v12
  v_bfe_u32 v14, v0, 3, 1
  v_lshl_or_b32 v14, v13, 1, v14
  v_xor_b32 v8, 0, v14
  v_lshl_add_u32 v60, v8, 5, v12
  v_xor_b32 v8, 1, v14
  v_lshl_add_u32 v61, v8, 5, v12
  v_xor_b32 v8, 2, v14
  v_lshl_add_u32 v62, v8, 5, v12
  v_xor_b32 v8, 3, v14
  v_lshl_add_u32 v63, v8, 5, v12
  v_mov_b32 v144, 0
  v_mov_b32 v145, 0
  v_mov_b32 v146, 0
  v_mov_b32 v147, 0
  v_mov_b32 v148, 0
  v_mov_b32 v149, 0
  v_mov_b32 v150, 0
  v_mov_b32 v151, 0
  v_mov_b32 v152, 0
  v_mov_b32 v153, 0
  v_mov_b32 v154, 0
  v_mov_b32 v155, 0
  v_mov_b32 v156, 0
  v_mov_b32 v157, 0
  v_mov_b32 v158, 0
  v_mov_b32 v159, 0
  v_mov_b32 v160, 0
  v_mov_b32 v161, 0
  v_mov_b32 v162, 0
  v_mov_b32 v163, 0
  v_mov_b32 v164, 0
  v_mov_b32 v165, 0
  v_mov_b32 v166, 0
  v_mov_b32 v167, 0
  v_mov_b32 v168, 0
  v_mov_b32 v169, 0
  v_mov_b32 v170, 0
  v_mov_b32 v171, 0
  v_mov_b32 v172, 0
  v_mov_b32 v173, 0
  v_mov_b32 v174, 0
  v_mov_b32 v175, 0
  v_mov_b32 v176, 0
  v_mov_b32 v177, 0
  v_mov_b32 v178, 0
  v_mov_b32 v179, 0
  v_mov_b32 v180, 0
  v_mov_b32 v181, 0
  v_mov_b32 v182, 0
  v_mov_b32 v183, 0
  v_mov_b32 v184, 0
  v_mov_b32 v185, 0
  v_mov_b32 v186, 0
  v_mov_b32 v187, 0
  v_mov_b32 v188, 0
  v_mov_b32 v189, 0
  v_mov_b32 v190, 0
  v_mov_b32 v191, 0
  v_mov_b32 v192, 0
  v_mov_b32 v193, 0
  v_mov_b32 v194, 0
  v_mov_b32 v195, 0
  v_mov_b32 v196, 0
  v_mov_b32 v197, 0
  v_mov_b32 v198, 0
  v_mov_b32 v199, 0
  v_mov_b32 v200, 0
  v_mov_b32 v201, 0
  v_mov_b32 v202, 0
  v_mov_b32 v203, 0
  v_mov_b32 v204, 0
  v_mov_b32 v205, 0
  v_mov_b32 v206, 0
  v_mov_b32 v207, 0
  v_mov_b32 v208, 0
  v_mov_b32 v209, 0
  v_mov_b32 v210, 0
  v_mov_b32 v211, 0
  v_mov_b32 v212, 0
  v_mov_b32 v213, 0
  v_mov_b32 v214, 0
  v_mov_b32 v215, 0
  v_mov_b32 v216, 0
  v_mov_b32 v217, 0
  v_mov_b32 v218, 0
  v_mov_b32 v219, 0
  v_mov_b32 v220, 0
  v_mov_b32 v221, 0
  v_mov_b32 v222, 0
  v_mov_b32 v223, 0
  v_mov_b32 v224, 0
  v_mov_b32 v225, 0
  v_mov_b32 v226, 0
  v_mov_b32 v227, 0
  v_mov_b32 v228, 0
  v_mov_b32 v229, 0
  v_mov_b32 v230, 0
  v_mov_b32 v231, 0
  v_mov_b32 v232, 0
  v_mov_b32 v233, 0
  v_mov_b32 v234, 0
  v_mov_b32 v235, 0
  v_mov_b32 v236, 0
  v_mov_b32 v237, 0
  v_mov_b32 v238, 0
  v_mov_b32 v239, 0
  v_mov_b32 v240, 0
  v_mov_b32 v241, 0
  v_mov_b32 v242, 0
  v_mov_b32 v243, 0
  v_mov_b32 v244, 0
  v_mov_b32 v245, 0
  v_mov_b32 v246, 0
  v_mov_b32 v247, 0
  v_mov_b32 v248, 0
  v_mov_b32 v249, 0
  v_mov_b32 v250, 0
  v_mov_b32 v251, 0
  v_mov_b32 v252, 0
  v_mov_b32 v253, 0
  v_mov_b32 v254, 0
  v_mov_b32 v255, 0
  s_add_u32 m0, s10, 0
  s_nop 0
  buffer_load_dwordx4 v1, s[56:59], s13 offen lds
  s_add_u32 m0, s10, 1024
  s_add_u32 s11, s13, s79
  buffer_load_dwordx4 v1, s[56:59], s11 offen lds
  s_add_u32 m0, s10, 2048
  s_nop 0
  buffer_load_dwordx4 v15, s[60:63], s13 offen lds
  s_add_u32 m0, s10, 3072
  s_add_u32 s11, s13, s79
  buffer_load_dwordx4 v15, s[60:63], s11 offen lds
  s_add_u32 s13, s13, s80
  s_waitcnt vmcnt(14)
  v_lshlrev_b32 v2, 16, v2
  s_waitcnt vmcnt(13)
  v_lshlrev_b32 v64, 16, v16
  v_and_b32 v65, s12, v16
  v_lshlrev_b32 v66, 16, v17
  v_and_b32 v67, s12, v17
  v_lshlrev_b32 v68, 16, v18
  v_and_b32 v69, s12, v18
  v_lshlrev_b32 v70, 16, v19
  v_and_b32 v71, s12, v19
  v_pk_add_f32 v[64:65], v[64:65], v[2:3] op_sel_hi:[1,0] neg_lo:[0,1] neg_hi:[0,1]
  v_pk_add_f32 v[66:67], v[66:67], v[2:3] op_sel_hi:[1,0] neg_lo:[0,1] neg_hi:[0,1]
  v_pk_add_f32 v[68:69], v[68:69], v[2:3] op_sel_hi:[1,0] neg_lo:[0,1] neg_hi:[0,1]
  v_pk_add_f32 v[70:71], v[70:71], v[2:3] op_sel_hi:[1,0] neg_lo:[0,1] neg_hi:[0,1]
  v_pk_add_f32 v[4:5], v[4:5], v[64:65]
  v_pk_fma_f32 v[6:7], v[64:65], v[64:65], v[6:7]
  v_pk_add_f32 v[4:5], v[4:5], v[66:67]
  v_pk_fma_f32 v[6:7], v[66:67], v[66:67], v[6:7]
  v_pk_add_f32 v[4:5], v[4:5], v[68:69]
  v_pk_fma_f32 v[6:7], v[68:69], v[68:69], v[6:7]
  v_pk_add_f32 v[4:5], v[4:5], v[70:71]
  v_pk_fma_f32 v[6:7], v[70:71], v[70:71], v[6:7]
  s_waitcnt vmcnt(12)
  v_lshlrev_b32 v72, 16, v20
  v_and_b32 v73, s12, v20
  v_lshlrev_b32 v74, 16, v21
  v_and_b32 v75, s12, v21
  v_lshlrev_b32 v76, 16, v22
  v_and_b32 v77, s12, v22
  v_lshlrev_b32 v78, 16, v23
  v_and_b32 v79, s12, v23
  v_pk_add_f32 v[72:73], v[72:73], v[2:3] op_sel_hi:[1,0] neg_lo:[0,1] neg_hi:[0,1]
  v_pk_add_f32 v[74:75], v[74:75], v[2:3] op_sel_hi:[1,0] neg_lo:[0,1] neg_hi:[0,1]
  v_pk_add_f32 v[76:77], v[76:77], v[2:3] op_sel_hi:[1,0] neg_lo:[0,1] neg_hi:[0,1]
  v_pk_add_f32 v[78:79], v[78:79], v[2:3] op_sel_hi:[1,0] neg_lo:[0,1] neg_hi:[0,1]
  v_pk_add_f32 v[4:5], v[4:5], v[72:73]
  v_pk_fma_f32 v[6:7], v[72:73], v[72:73], v[6:7]
  v_pk_add_f32 v[4:5], v[4:5], v[74:75]
  v_pk_fma_f32 v[6:7], v[74:75], v[74:75], v[6:7]
  v_pk_add_f32 v[4:5], v[4:5], v[76:77]
  v_pk_fma_f32 v[6:7], v[76:77], v[76:77], v[6:7]
  v_pk_add_f32 v[4:5], v[4:5], v[78:79]
  v_pk_fma_f32 v[6:7], v[78:79], v[78:79], v[6:7]
  s_waitcnt vmcnt(11)
  v_lshlrev_b32 v80, 16, v24
  v_and_b32 v81, s12, v24
  v_lshlrev_b32 v82, 16, v25
  v_and_b32 v83, s12, v25
  v_lshlrev_b32 v84, 16, v26
  v_and_b32 v85, s12, v26
  v_lshlrev_b32 v86, 16, v27
  v_and_b32 v87, s12, v27
  v_pk_add_f32 v[80:81], v[80:81], v[2:3] op_sel_hi:[1,0] neg_lo:[0,1] neg_hi:[0,1]
  v_pk_add_f32 v[82:83], v[82:83], v[2:3] op_sel_hi:[1,0] neg_lo:[0,1] neg_hi:[0,1]
  v_pk_add_f32 v[84:85], v[84:85], v[2:3] op_sel_hi:[1,0] neg_lo:[0,1] neg_hi:[0,1]
  v_pk_add_f32 v[86:87], v[86:87], v[2:3] op_sel_hi:[1,0] neg_lo:[0,1] neg_hi:[0,1]
  v_pk_add_f32 v[4:5], v[4:5], v[80:81]
  v_pk_fma_f32 v[6:7], v[80:81], v[80:81], v[6:7]
  v_pk_add_f32 v[4:5], v[4:5], v[82:83]
  v_pk_fma_f32 v[6:7], v[82:83], v[82:83], v[6:7]
  v_pk_add_f32 v[4:5], v[4:5], v[84:85]
  v_pk_fma_f32 v[6:7], v[84:85], v[84:85], v[6:7]
  v_pk_add_f32 v[4:5], v[4:5], v[86:87]
  v_pk_fma_f32 v[6:7], v[86:87], v[86:87], v[6:7]
  s_waitcnt vmcnt(10)
  v_lshlrev_b32 v88, 16, v28
  v_and_b32 v89, s12, v28
  v_lshlrev_b32 v90, 16, v29
  v_and_b32 v91, s12, v29
  v_lshlrev_b32 v92, 16, v30
  v_and_b32 v93, s12, v30
  v_lshlrev_b32 v94, 16, v31
  v_and_b32 v95, s12, v31
  v_pk_add_f32 v[88:89], v[88:89], v[2:3] op_sel_hi:[1,0] neg_lo:[0,1] neg_hi:[0,1]
  v_pk_add_f32 v[90:91], v[90:91], v[2:3] op_sel_hi:[1,0] neg_lo:[0,1] neg_hi:[0,1]
  v_pk_add_f32 v[92:93], v[92:93], v[2:3] op_sel_hi:[1,0] neg_lo:[0,1] neg_hi:[0,1]
  v_pk_add_f32 v[94:95], v[94:95], v[2:3] op_sel_hi:[1,0] neg_lo:[0,1] neg_hi:[0,1]
  v_pk_add_f32 v[4:5], v[4:5], v[88:89]
  v_pk_fma_f32 v[6:7], v[88:89], v[88:89], v[6:7]
  v_pk_add_f32 v[4:5], v[4:5], v[90:91]
  v_pk_fma_f32 v[6:7], v[90:91], v[90:91], v[6:7]
  v_pk_add_f32 v[4:5], v[4:5], v[92:93]
  v_pk_fma_f32 v[6:7], v[92:93], v[92:93], v[6:7]
  v_pk_add_f32 v[4:5], v[4:5], v[94:95]
  v_pk_fma_f32 v[6:7], v[94:95], v[94:95], v[6:7]
  s_waitcnt vmcnt(9)
  v_lshlrev_b32 v96, 16, v32
  v_and_b32 v97, s12, v32
  v_lshlrev_b32 v98, 16, v33
  v_and_b32 v99, s12, v33
  v_lshlrev_b32 v100, 16, v34
  v_and_b32 v101, s12, v34
  v_lshlrev_b32 v102, 16, v35
  v_and_b32 v103, s12, v35
  v_pk_add_f32 v[96:97], v[96:97], v[2:3] op_sel_hi:[1,0] neg_lo:[0,1] neg_hi:[0,1]
  v_pk_add_f32 v[98:99], v[98:99], v[2:3] op_sel_hi:[1,0] neg_lo:[0,1] neg_hi:[0,1]
  v_pk_add_f32 v[100:101], v[100:101], v[2:3] op_sel_hi:[1,0] neg_lo:[0,1] neg_hi:[0,1]
  v_pk_add_f32 v[102:103], v[102:103], v[2:3] op_sel_hi:[1,0] neg_lo:[0,1] neg_hi:[0,1]
  v_pk_add_f32 v[4:5], v[4:5], v[96:97]
  v_pk_fma_f32 v[6:7], v[96:97], v[96:97], v[6:7]
  v_pk_add_f32 v[4:5], v[4:5], v[98:99]
  v_pk_fma_f32 v[6:7], v[98:99], v[98:99], v[6:7]
  v_pk_add_f32 v[4:5], v[4:5], v[100:101]
  v_pk_fma_f32 v[6:7], v[100:101], v[100:101], v[6:7]
  v_pk_add_f32 v[4:5], v[4:5], v[102:103]
  v_pk_fma_f32 v[6:7], v[102:103], v[102:103], v[6:7]
  s_waitcnt vmcnt(8)
  v_lshlrev_b32 v104, 16, v36
  v_and_b32 v105, s12, v36
  v_lshlrev_b32 v106, 16, v37
  v_and_b32 v107, s12, v37
  v_lshlrev_b32 v108, 16, v38
  v_and_b32 v109, s12, v38
  v_lshlrev_b32 v110, 16, v39
  v_and_b32 v111, s12, v39
  v_pk_add_f32 v[104:105], v[104:105], v[2:3] op_sel_hi:[1,0] neg_lo:[0,1] neg_hi:[0,1]
  v_pk_add_f32 v[106:107], v[106:107], v[2:3] op_sel_hi:[1,0] neg_lo:[0,1] neg_hi:[0,1]
  v_pk_add_f32 v[108:109], v[108:109], v[2:3] op_sel_hi:[1,0] neg_lo:[0,1] neg_hi:[0,1]
  v_pk_add_f32 v[110:111], v[110:111], v[2:3] op_sel_hi:[1,0] neg_lo:[0,1] neg_hi:[0,1]
  v_pk_add_f32 v[4:5], v[4:5], v[104:105]
  v_pk_fma_f32 v[6:7], v[104:105], v[104:105], v[6:7]
  v_pk_add_f32 v[4:5], v[4:5], v[106:107]
  v_pk_fma_f32 v[6:7], v[106:107], v[106:107], v[6:7]
  v_pk_add_f32 v[4:5], v[4:5], v[108:109]
  v_pk_fma_f32 v[6:7], v[108:109], v[108:109], v[6:7]
  v_pk_add_f32 v[4:5], v[4:5], v[110:111]
  v_pk_fma_f32 v[6:7], v[110:111], v[110:111], v[6:7]
  s_waitcnt vmcnt(7)
  v_lshlrev_b32 v112, 16, v40
  v_and_b32 v113, s12, v40
  v_lshlrev_b32 v114, 16, v41
  v_and_b32 v115, s12, v41
  v_lshlrev_b32 v116, 16, v42
  v_and_b32 v117, s12, v42
  v_lshlrev_b32 v118, 16, v43
  v_and_b32 v119, s12, v43
  v_pk_add_f32 v[112:113], v[112:113], v[2:3] op_sel_hi:[1,0] neg_lo:[0,1] neg_hi:[0,1]
  v_pk_add_f32 v[114:115], v[114:115], v[2:3] op_sel_hi:[1,0] neg_lo:[0,1] neg_hi:[0,1]
  v_pk_add_f32 v[116:117], v[116:117], v[2:3] op_sel_hi:[1,0] neg_lo:[0,1] neg_hi:[0,1]
  v_pk_add_f32 v[118:119], v[118:119], v[2:3] op_sel_hi:[1,0] neg_lo:[0,1] neg_hi:[0,1]
  v_pk_add_f32 v[4:5], v[4:5], v[112:113]
  v_pk_fma_f32 v[6:7], v[112:113], v[112:113], v[6:7]
  v_pk_add_f32 v[4:5], v[4:5], v[114:115]
  v_pk_fma_f32 v[6:7], v[114:115], v[114:115], v[6:7]
  v_pk_add_f32 v[4:5], v[4:5], v[116:117]
  v_pk_fma_f32 v[6:7], v[116:117], v[116:117], v[6:7]
  v_pk_add_f32 v[4:5], v[4:5], v[118:119]
  v_pk_fma_f32 v[6:7], v[118:119], v[118:119], v[6:7]
  s_waitcnt vmcnt(6)
  v_lshlrev_b32 v120, 16, v44
  v_and_b32 v121, s12, v44
  v_lshlrev_b32 v122, 16, v45
  v_and_b32 v123, s12, v45
  v_lshlrev_b32 v124, 16, v46
  v_and_b32 v125, s12, v46
  v_lshlrev_b32 v126, 16, v47
  v_and_b32 v127, s12, v47
  v_pk_add_f32 v[120:121], v[120:121], v[2:3] op_sel_hi:[1,0] neg_lo:[0,1] neg_hi:[0,1]
  v_pk_add_f32 v[122:123], v[122:123], v[2:3] op_sel_hi:[1,0] neg_lo:[0,1] neg_hi:[0,1]
  v_pk_add_f32 v[124:125], v[124:125], v[2:3] op_sel_hi:[1,0] neg_lo:[0,1] neg_hi:[0,1]
  v_pk_add_f32 v[126:127], v[126:127], v[2:3] op_sel_hi:[1,0] neg_lo:[0,1] neg_hi:[0,1]
  v_pk_add_f32 v[4:5], v[4:5], v[120:121]
  v_pk_fma_f32 v[6:7], v[120:121], v[120:121], v[6:7]
  v_pk_add_f32 v[4:5], v[4:5], v[122:123]
  v_pk_fma_f32 v[6:7], v[122:123], v[122:123], v[6:7]
  v_pk_add_f32 v[4:5], v[4:5], v[124:125]
  v_pk_fma_f32 v[6:7], v[124:125], v[124:125], v[6:7]
  v_pk_add_f32 v[4:5], v[4:5], v[126:127]
  v_pk_fma_f32 v[6:7], v[126:127], v[126:127], v[6:7]
  s_waitcnt vmcnt(5)
  v_lshlrev_b32 v128, 16, v48
  v_and_b32 v129, s12, v48
  v_lshlrev_b32 v130, 16, v49
  v_and_b32 v131, s12, v49
  v_lshlrev_b32 v132, 16, v50
  v_and_b32 v133, s12, v50
  v_lshlrev_b32 v134, 16, v51
  v_and_b32 v135, s12, v51
  v_pk_add_f32 v[128:129], v[128:129], v[2:3] op_sel_hi:[1,0] neg_lo:[0,1] neg_hi:[0,1]
  v_pk_add_f32 v[130:131], v[130:131], v[2:3] op_sel_hi:[1,0] neg_lo:[0,1] neg_hi:[0,1]
  v_pk_add_f32 v[132:133], v[132:133], v[2:3] op_sel_hi:[1,0] neg_lo:[0,1] neg_hi:[0,1]
  v_pk_add_f32 v[134:135], v[134:135], v[2:3] op_sel_hi:[1,0] neg_lo:[0,1] neg_hi:[0,1]
  v_pk_add_f32 v[4:5], v[4:5], v[128:129]
  v_pk_fma_f32 v[6:7], v[128:129], v[128:129], v[6:7]
  v_pk_add_f32 v[4:5], v[4:5], v[130:131]
  v_pk_fma_f32 v[6:7], v[130:131], v[130:131], v[6:7]
  v_pk_add_f32 v[4:5], v[4:5], v[132:133]
  v_pk_fma_f32 v[6:7], v[132:133], v[132:133], v[6:7]
  v_pk_add_f32 v[4:5], v[4:5], v[134:135]
  v_pk_fma_f32 v[6:7], v[134:135], v[134:135], v[6:7]
  s_waitcnt vmcnt(4)
  v_lshlrev_b32 v136, 16, v52
  v_and_b32 v137, s12, v52
  v_lshlrev_b32 v138, 16, v53
  v_and_b32 v139, s12, v53
  v_lshlrev_b32 v140, 16, v54
  v_and_b32 v141, s12, v54
  v_lshlrev_b32 v142, 16, v55
  v_and_b32 v143, s12, v55
  v_pk_add_f32 v[136:137], v[136:137], v[2:3] op_sel_hi:[1,0] neg_lo:[0,1] neg_hi:[0,1]
  v_pk_add_f32 v[138:139], v[138:139], v[2:3] op_sel_hi:[1,0] neg_lo:[0,1] neg_hi:[0,1]
  v_pk_add_f32 v[140:141], v[140:141], v[2:3] op_sel_hi:[1,0] neg_lo:[0,1] neg_hi:[0,1]
  v_pk_add_f32 v[142:143], v[142:143], v[2:3] op_sel_hi:[1,0] neg_lo:[0,1] neg_hi:[0,1]
  v_pk_add_f32 v[4:5], v[4:5], v[136:137]
  v_pk_fma_f32 v[6:7], v[136:137], v[136:137], v[6:7]
  v_pk_add_f32 v[4:5], v[4:5], v[138:139]
  v_pk_fma_f32 v[6:7], v[138:139], v[138:139], v[6:7]
  v_pk_add_f32 v[4:5], v[4:5], v[140:141]
  v_pk_fma_f32 v[6:7], v[140:141], v[140:141], v[6:7]
  v_pk_add_f32 v[4:5], v[4:5], v[142:143]
  v_pk_fma_f32 v[6:7], v[142:143], v[142:143], v[6:7]
  s_add_u32 m0, s10, 4096
  s_nop 0
  buffer_load_dwordx4 v1, s[56:59], s13 offen lds
  s_add_u32 m0, s10, 5120
  s_add_u32 s11, s13, s79
  buffer_load_dwordx4 v1, s[56:59], s11 offen lds
  v_add_f32 v4, v4, v5
  v_add_f32 v6, v6, v7
  s_nop 1
  v_add_f32_dpp v4, v4, v4 quad_perm:[1,0,3,2] row_mask:0xf bank_mask:0xf
  v_add_f32_dpp v6, v6, v6 quad_perm:[1,0,3,2] row_mask:0xf bank_mask:0xf
  s_nop 1
  v_add_f32_dpp v4, v4, v4 quad_perm:[2,3,0,1] row_mask:0xf bank_mask:0xf
  v_add_f32_dpp v6, v6, v6 quad_perm:[2,3,0,1] row_mask:0xf bank_mask:0xf
  s_nop 1
  v_add_f32_dpp v4, v4, v4 row_half_mirror row_mask:0xf bank_mask:0xf
  v_add_f32_dpp v6, v6, v6 row_half_mirror row_mask:0xf bank_mask:0xf
  v_mul_f32 v4, 0x3acccccd, v4
  v_mul_f32 v6, 0x3acccccd, v6
  v_fma_f32 v6, -v4, v4, v6
  v_max_f32 v6, 0, v6
  v_add_f32 v6, 0x3727c5ac, v6
  v_rsq_f32 v6, v6
  s_and_b32 s7, s85, 3
  s_lshl_b32 s7, s7, 3
  v_mul_f32 v4, v4, v6
  v_add_u32 v8, s7, v10
  v_and_b32 v9, 1, v11
  v_lshl_add_u32 v8, v9, 5, v8
  v_xor_b32 v8, v8, v11
  v_lshlrev_b32 v8, 4, v8
  v_lshrrev_b32 v9, 1, v11
  v_lshl_add_u32 v8, v9, 11, v8
  s_lshr_b32 s7, s85, 2
  s_lshl_b32 s7, s7, 10
  v_add_u32 v8, s7, v8
  v_add_u32 v9, 0x10000, v8
  v_pk_fma_f32 v[64:65], v[64:65], v[6:7], v[4:5] op_sel_hi:[1,0,0] neg_lo:[0,0,1] neg_hi:[0,0,1]
  v_pk_fma_f32 v[66:67], v[66:67], v[6:7], v[4:5] op_sel_hi:[1,0,0] neg_lo:[0,0,1] neg_hi:[0,0,1]
  v_pk_fma_f32 v[68:69], v[68:69], v[6:7], v[4:5] op_sel_hi:[1,0,0] neg_lo:[0,0,1] neg_hi:[0,0,1]
  v_pk_fma_f32 v[70:71], v[70:71], v[6:7], v[4:5] op_sel_hi:[1,0,0] neg_lo:[0,0,1] neg_hi:[0,0,1]
  v_cvt_pk_bf16_f32 v16, v64, v65
  v_cvt_pk_bf16_f32 v17, v66, v67
  v_cvt_pk_bf16_f32 v18, v68, v69
  v_cvt_pk_bf16_f32 v19, v70, v71
  ds_write_b128 v8, v[16:19] offset:0
  s_add_u32 m0, s10, 6144
  s_nop 0
  buffer_load_dwordx4 v15, s[60:63], s13 offen lds
  v_pk_fma_f32 v[72:73], v[72:73], v[6:7], v[4:5] op_sel_hi:[1,0,0] neg_lo:[0,0,1] neg_hi:[0,0,1]
  v_pk_fma_f32 v[74:75], v[74:75], v[6:7], v[4:5] op_sel_hi:[1,0,0] neg_lo:[0,0,1] neg_hi:[0,0,1]
  v_pk_fma_f32 v[76:77], v[76:77], v[6:7], v[4:5] op_sel_hi:[1,0,0] neg_lo:[0,0,1] neg_hi:[0,0,1]
  v_pk_fma_f32 v[78:79], v[78:79], v[6:7], v[4:5] op_sel_hi:[1,0,0] neg_lo:[0,0,1] neg_hi:[0,0,1]
  v_cvt_pk_bf16_f32 v20, v72, v73
  v_cvt_pk_bf16_f32 v21, v74, v75
  v_cvt_pk_bf16_f32 v22, v76, v77
  v_cvt_pk_bf16_f32 v23, v78, v79
  ds_write_b128 v8, v[20:23] offset:8192
  s_add_u32 m0, s10, 7168
  s_add_u32 s11, s13, s79
  buffer_load_dwordx4 v15, s[60:63], s11 offen lds
  s_add_u32 s13, s13, s80
  v_pk_fma_f32 v[80:81], v[80:81], v[6:7], v[4:5] op_sel_hi:[1,0,0] neg_lo:[0,0,1] neg_hi:[0,0,1]
  v_pk_fma_f32 v[82:83], v[82:83], v[6:7], v[4:5] op_sel_hi:[1,0,0] neg_lo:[0,0,1] neg_hi:[0,0,1]
  v_pk_fma_f32 v[84:85], v[84:85], v[6:7], v[4:5] op_sel_hi:[1,0,0] neg_lo:[0,0,1] neg_hi:[0,0,1]
  v_pk_fma_f32 v[86:87], v[86:87], v[6:7], v[4:5] op_sel_hi:[1,0,0] neg_lo:[0,0,1] neg_hi:[0,0,1]
  v_cvt_pk_bf16_f32 v24, v80, v81
  v_cvt_pk_bf16_f32 v25, v82, v83
  v_cvt_pk_bf16_f32 v26, v84, v85
  v_cvt_pk_bf16_f32 v27, v86, v87
  ds_write_b128 v8, v[24:27] offset:16384
  s_add_u32 m0, s10, 8192
  s_nop 0
  buffer_load_dwordx4 v1, s[56:59], s13 offen lds
  v_pk_fma_f32 v[88:89], v[88:89], v[6:7], v[4:5] op_sel_hi:[1,0,0] neg_lo:[0,0,1] neg_hi:[0,0,1]
  v_pk_fma_f32 v[90:91], v[90:91], v[6:7], v[4:5] op_sel_hi:[1,0,0] neg_lo:[0,0,1] neg_hi:[0,0,1]
  v_pk_fma_f32 v[92:93], v[92:93], v[6:7], v[4:5] op_sel_hi:[1,0,0] neg_lo:[0,0,1] neg_hi:[0,0,1]
  v_pk_fma_f32 v[94:95], v[94:95], v[6:7], v[4:5] op_sel_hi:[1,0,0] neg_lo:[0,0,1] neg_hi:[0,0,1]
  v_cvt_pk_bf16_f32 v28, v88, v89
  v_cvt_pk_bf16_f32 v29, v90, v91
  v_cvt_pk_bf16_f32 v30, v92, v93
  v_cvt_pk_bf16_f32 v31, v94, v95
  ds_write_b128 v8, v[28:31] offset:24576
  s_add_u32 m0, s10, 9216
  s_add_u32 s11, s13, s79
  buffer_load_dwordx4 v1, s[56:59], s11 offen lds
  v_pk_fma_f32 v[96:97], v[96:97], v[6:7], v[4:5] op_sel_hi:[1,0,0] neg_lo:[0,0,1] neg_hi:[0,0,1]
  v_pk_fma_f32 v[98:99], v[98:99], v[6:7], v[4:5] op_sel_hi:[1,0,0] neg_lo:[0,0,1] neg_hi:[0,0,1]
  v_pk_fma_f32 v[100:101], v[100:101], v[6:7], v[4:5] op_sel_hi:[1,0,0] neg_lo:[0,0,1] neg_hi:[0,0,1]
  v_pk_fma_f32 v[102:103], v[102:103], v[6:7], v[4:5] op_sel_hi:[1,0,0] neg_lo:[0,0,1] neg_hi:[0,0,1]
  v_cvt_pk_bf16_f32 v32, v96, v97
  v_cvt_pk_bf16_f32 v33, v98, v99
  v_cvt_pk_bf16_f32 v34, v100, v101
  v_cvt_pk_bf16_f32 v35, v102, v103
  ds_write_b128 v8, v[32:35] offset:32768
  s_add_u32 m0, s10, 10240
  s_nop 0
  buffer_load_dwordx4 v15, s[60:63], s13 offen lds
  v_pk_fma_f32 v[104:105], v[104:105], v[6:7], v[4:5] op_sel_hi:[1,0,0] neg_lo:[0,0,1] neg_hi:[0,0,1]
  v_pk_fma_f32 v[106:107], v[106:107], v[6:7], v[4:5] op_sel_hi:[1,0,0] neg_lo:[0,0,1] neg_hi:[0,0,1]
  v_pk_fma_f32 v[108:109], v[108:109], v[6:7], v[4:5] op_sel_hi:[1,0,0] neg_lo:[0,0,1] neg_hi:[0,0,1]
  v_pk_fma_f32 v[110:111], v[110:111], v[6:7], v[4:5] op_sel_hi:[1,0,0] neg_lo:[0,0,1] neg_hi:[0,0,1]
  v_cvt_pk_bf16_f32 v36, v104, v105
  v_cvt_pk_bf16_f32 v37, v106, v107
  v_cvt_pk_bf16_f32 v38, v108, v109
  v_cvt_pk_bf16_f32 v39, v110, v111
  ds_write_b128 v8, v[36:39] offset:40960
  s_add_u32 m0, s10, 11264
  s_add_u32 s11, s13, s79
  buffer_load_dwordx4 v15, s[60:63], s11 offen lds
  s_add_u32 s13, s13, s80
  v_pk_fma_f32 v[112:113], v[112:113], v[6:7], v[4:5] op_sel_hi:[1,0,0] neg_lo:[0,0,1] neg_hi:[0,0,1]
  v_pk_fma_f32 v[114:115], v[114:115], v[6:7], v[4:5] op_sel_hi:[1,0,0] neg_lo:[0,0,1] neg_hi:[0,0,1]
  v_pk_fma_f32 v[116:117], v[116:117], v[6:7], v[4:5] op_sel_hi:[1,0,0] neg_lo:[0,0,1] neg_hi:[0,0,1]
  v_pk_fma_f32 v[118:119], v[118:119], v[6:7], v[4:5] op_sel_hi:[1,0,0] neg_lo:[0,0,1] neg_hi:[0,0,1]
  v_cvt_pk_bf16_f32 v40, v112, v113
  v_cvt_pk_bf16_f32 v41, v114, v115
  v_cvt_pk_bf16_f32 v42, v116, v117
  v_cvt_pk_bf16_f32 v43, v118, v119
  ds_write_b128 v8, v[40:43] offset:49152
  s_add_u32 m0, s10, 12288
  s_nop 0
  buffer_load_dwordx4 v1, s[56:59], s13 offen lds
  v_pk_fma_f32 v[120:121], v[120:121], v[6:7], v[4:5] op_sel_hi:[1,0,0] neg_lo:[0,0,1] neg_hi:[0,0,1]
  v_pk_fma_f32 v[122:123], v[122:123], v[6:7], v[4:5] op_sel_hi:[1,0,0] neg_lo:[0,0,1] neg_hi:[0,0,1]
  v_pk_fma_f32 v[124:125], v[124:125], v[6:7], v[4:5] op_sel_hi:[1,0,0] neg_lo:[0,0,1] neg_hi:[0,0,1]
  v_pk_fma_f32 v[126:127], v[126:127], v[6:7], v[4:5] op_sel_hi:[1,0,0] neg_lo:[0,0,1] neg_hi:[0,0,1]
  v_cvt_pk_bf16_f32 v44, v120, v121
  v_cvt_pk_bf16_f32 v45, v122, v123
  v_cvt_pk_bf16_f32 v46, v124, v125
  v_cvt_pk_bf16_f32 v47, v126, v127
  ds_write_b128 v8, v[44:47] offset:57344
  s_add_u32 m0, s10, 13312
  s_add_u32 s11, s13, s79
  buffer_load_dwordx4 v1, s[56:59], s11 offen lds
  v_pk_fma_f32 v[128:129], v[128:129], v[6:7], v[4:5] op_sel_hi:[1,0,0] neg_lo:[0,0,1] neg_hi:[0,0,1]
  v_pk_fma_f32 v[130:131], v[130:131], v[6:7], v[4:5] op_sel_hi:[1,0,0] neg_lo:[0,0,1] neg_hi:[0,0,1]
  v_pk_fma_f32 v[132:133], v[132:133], v[6:7], v[4:5] op_sel_hi:[1,0,0] neg_lo:[0,0,1] neg_hi:[0,0,1]
  v_pk_fma_f32 v[134:135], v[134:135], v[6:7], v[4:5] op_sel_hi:[1,0,0] neg_lo:[0,0,1] neg_hi:[0,0,1]
  v_cvt_pk_bf16_f32 v48, v128, v129
  v_cvt_pk_bf16_f32 v49, v130, v131
  v_cvt_pk_bf16_f32 v50, v132, v133
  v_cvt_pk_bf16_f32 v51, v134, v135
  ds_write_b128 v9, v[48:51] offset:0
  s_add_u32 m0, s10, 14336
  s_nop 0
  buffer_load_dwordx4 v15, s[60:63], s13 offen lds
  v_pk_fma_f32 v[136:137], v[136:137], v[6:7], v[4:5] op_sel_hi:[1,0,0] neg_lo:[0,0,1] neg_hi:[0,0,1]
  v_pk_fma_f32 v[138:139], v[138:139], v[6:7], v[4:5] op_sel_hi:[1,0,0] neg_lo:[0,0,1] neg_hi:[0,0,1]
  v_pk_fma_f32 v[140:141], v[140:141], v[6:7], v[4:5] op_sel_hi:[1,0,0] neg_lo:[0,0,1] neg_hi:[0,0,1]
  v_pk_fma_f32 v[142:143], v[142:143], v[6:7], v[4:5] op_sel_hi:[1,0,0] neg_lo:[0,0,1] neg_hi:[0,0,1]
  v_cvt_pk_bf16_f32 v52, v136, v137
  v_cvt_pk_bf16_f32 v53, v138, v139
  v_cvt_pk_bf16_f32 v54, v140, v141
  v_cvt_pk_bf16_f32 v55, v142, v143
  ds_write_b128 v9, v[52:55] offset:8192
  s_add_u32 m0, s10, 15360
  s_add_u32 s11, s13, s79
  buffer_load_dwordx4 v15, s[60:63], s11 offen lds
  s_add_u32 s13, s13, s80
  v_mov_b32 v128, 0
  v_mov_b32 v129, 0
  v_mov_b32 v130, 0
  v_mov_b32 v131, 0
  v_mov_b32 v132, 0
  v_mov_b32 v133, 0
  v_mov_b32 v134, 0
  v_mov_b32 v135, 0
  v_mov_b32 v136, 0
  v_mov_b32 v137, 0
  v_mov_b32 v138, 0
  v_mov_b32 v139, 0
  v_mov_b32 v140, 0
  v_mov_b32 v141, 0
  v_mov_b32 v142, 0
  v_mov_b32 v143, 0
  s_waitcnt lgkmcnt(0)
  s_add_u32 s84, s84, 1
  s_mul_i32 s15, s84, 0x9e3779b1
  s_or_b32 s15, s15, 1
  s_barrier
  s_setprio 2
  s_waitcnt vmcnt(12)
  ds_read_b128 v[80:83], v56 offset:0
  ds_read_b128 v[84:87], v56 offset:1024
  ds_read_b64_tr_b16 v[64:65], v60 offset:0
  ds_read_b64_tr_b16 v[66:67], v60 offset:512
  ds_read_b64_tr_b16 v[68:69], v61 offset:0
  ds_read_b64_tr_b16 v[70:71], v61 offset:512
  ds_read_b64_tr_b16 v[72:73], v62 offset:0
  ds_read_b64_tr_b16 v[74:75], v62 offset:512
  ds_read_b64_tr_b16 v[76:77], v63 offset:0
  ds_read_b64_tr_b16 v[78:79], v63 offset:512
  s_waitcnt lgkmcnt(0)
  s_add_u32 m0, s10, 0
  s_nop 0
  buffer_load_dwordx4 v1, s[56:59], s13 offen lds
  s_add_u32 m0, s10, 1024
  s_add_u32 s11, s13, s79
  buffer_load_dwordx4 v1, s[56:59], s11 offen lds
  s_add_u32 m0, s10, 2048
  s_nop 0
  buffer_load_dwordx4 v15, s[60:63], s13 offen lds
  s_add_u32 m0, s10, 3072
  s_add_u32 s11, s13, s79
  buffer_load_dwordx4 v15, s[60:63], s11 offen lds
  s_add_u32 s13, s13, s80
  s_mov_b32 s8, 10
  s_setprio 2
.p2align 6
f1_loop:
  s_waitcnt vmcnt(12) lgkmcnt(0)
  v_mfma_f32_32x32x16_bf16 v[128:143], v[64:67], v[80:83], v[128:143]
  ds_read_b64_tr_b16 v[88:89], v60 offset:4096
  ds_read_b64_tr_b16 v[90:91], v60 offset:4608
  ds_read_b64_tr_b16 v[92:93], v61 offset:4096
  ds_read_b64_tr_b16 v[94:95], v61 offset:4608
  v_mfma_f32_32x32x16_bf16 v[144:159], v[64:67], v[84:87], v[144:159]
  ds_read_b64_tr_b16 v[96:97], v62 offset:4096
  ds_read_b64_tr_b16 v[98:99], v62 offset:4608
  ds_read_b64_tr_b16 v[100:101], v63 offset:4096
  ds_read_b64_tr_b16 v[102:103], v63 offset:4608
  v_mfma_f32_32x32x16_bf16 v[160:175], v[68:71], v[80:83], v[160:175]
  ds_read_b128 v[104:107], v57 offset:2048
  ds_read_b128 v[108:111], v57 offset:3072
  v_mfma_f32_32x32x16_bf16 v[176:191], v[68:71], v[84:87], v[176:191]
  v_mfma_f32_32x32x16_bf16 v[192:207], v[72:75], v[80:83], v[192:207]
  s_waitcnt lgkmcnt(2)
  s_add_u32 m0, s10, 4096
  s_nop 0
  buffer_load_dwordx4 v1, s[56:59], s13 offen lds
  v_mfma_f32_32x32x16_bf16 v[208:223], v[72:75], v[84:87], v[208:223]
  s_add_u32 m0, s10, 5120
  s_add_u32 s11, s13, s79
  buffer_load_dwordx4 v1, s[56:59], s11 offen lds
  v_mfma_f32_32x32x16_bf16 v[224:239], v[76:79], v[80:83], v[224:239]
  s_add_u32 m0, s10, 6144
  s_nop 0
  buffer_load_dwordx4 v15, s[60:63], s13 offen lds
  v_mfma_f32_32x32x16_bf16 v[240:255], v[76:79], v[84:87], v[240:255]
  s_add_u32 m0, s10, 7168
  s_add_u32 s11, s13, s79
  buffer_load_dwordx4 v15, s[60:63], s11 offen lds
  s_add_u32 s13, s13, s80
  s_waitcnt vmcnt(12) lgkmcnt(0)
  v_mfma_f32_32x32x16_bf16 v[128:143], v[88:91], v[104:107], v[128:143]
  ds_read_b64_tr_b16 v[64:65], v60 offset:8192
  ds_read_b64_tr_b16 v[66:67], v60 offset:8704
  ds_read_b64_tr_b16 v[68:69], v61 offset:8192
  ds_read_b64_tr_b16 v[70:71], v61 offset:8704
  v_mfma_f32_32x32x16_bf16 v[144:159], v[88:91], v[108:111], v[144:159]
  ds_read_b64_tr_b16 v[72:73], v62 offset:8192
  ds_read_b64_tr_b16 v[74:75], v62 offset:8704
  ds_read_b64_tr_b16 v[76:77], v63 offset:8192
  ds_read_b64_tr_b16 v[78:79], v63 offset:8704
  v_mfma_f32_32x32x16_bf16 v[160:175], v[92:95], v[104:107], v[160:175]
  ds_read_b128 v[80:83], v58 offset:4096
  ds_read_b128 v[84:87], v58 offset:5120
  v_mfma_f32_32x32x16_bf16 v[176:191], v[92:95], v[108:111], v[176:191]
  v_mfma_f32_32x32x16_bf16 v[192:207], v[96:99], v[104:107], v[192:207]
  s_waitcnt lgkmcnt(2)
  s_add_u32 m0, s10, 8192
  s_nop 0
  buffer_load_dwordx4 v1, s[56:59], s13 offen lds
  v_mfma_f32_32x32x16_bf16 v[208:223], v[96:99], v[108:111], v[208:223]
  s_add_u32 m0, s10, 9216
  s_add_u32 s11, s13, s79
  buffer_load_dwordx4 v1, s[56:59], s11 offen lds
  v_mfma_f32_32x32x16_bf16 v[224:239], v[100:103], v[104:107], v[224:239]
  s_add_u32 m0, s10, 10240
  s_nop 0
  buffer_load_dwordx4 v15, s[60:63], s13 offen lds
  v_mfma_f32_32x32x16_bf16 v[240:255], v[100:103], v[108:111], v[240:255]
  s_add_u32 m0, s10, 11264
  s_add_u32 s11, s13, s79
  buffer_load_dwordx4 v15, s[60:63], s11 offen lds
  s_add_u32 s13, s13, s80
  s_waitcnt vmcnt(12) lgkmcnt(0)
  v_mfma_f32_32x32x16_bf16 v[128:143], v[64:67], v[80:83], v[128:143]
  ds_read_b64_tr_b16 v[88:89], v60 offset:12288
  ds_read_b64_tr_b16 v[90:91], v60 offset:12800
  ds_read_b64_tr_b16 v[92:93], v61 offset:12288
  ds_read_b64_tr_b16 v[94:95], v61 offset:12800
  v_mfma_f32_32x32x16_bf16 v[144:159], v[64:67], v[84:87], v[144:159]
  ds_read_b64_tr_b16 v[96:97], v62 offset:12288
  ds_read_b64_tr_b16 v[98:99], v62 offset:12800
  ds_read_b64_tr_b16 v[100:101], v63 offset:12288
  ds_read_b64_tr_b16 v[102:103], v63 offset:12800
  v_mfma_f32_32x32x16_bf16 v[160:175], v[68:71], v[80:83], v[160:175]
  ds_read_b128 v[104:107], v59 offset:6144
  ds_read_b128 v[108:111], v59 offset:7168
  v_mfma_f32_32x32x16_bf16 v[176:191], v[68:71], v[84:87], v[176:191]
  v_mfma_f32_32x32x16_bf16 v[192:207], v[72:75], v[80:83], v[192:207]
  s_waitcnt lgkmcnt(2)
  s_add_u32 m0, s10, 12288
  s_nop 0
  buffer_load_dwordx4 v1, s[56:59], s13 offen lds
  v_mfma_f32_32x32x16_bf16 v[208:223], v[72:75], v[84:87], v[208:223]
  s_add_u32 m0, s10, 13312
  s_add_u32 s11, s13, s79
  buffer_load_dwordx4 v1, s[56:59], s11 offen lds
  v_mfma_f32_32x32x16_bf16 v[224:239], v[76:79], v[80:83], v[224:239]
  s_add_u32 m0, s10, 14336
  s_nop 0
  buffer_load_dwordx4 v15, s[60:63], s13 offen lds
  v_mfma_f32_32x32x16_bf16 v[240:255], v[76:79], v[84:87], v[240:255]
  s_add_u32 m0, s10, 15360
  s_add_u32 s11, s13, s79
  buffer_load_dwordx4 v15, s[60:63], s11 offen lds
  s_add_u32 s13, s13, s80
  s_waitcnt vmcnt(12) lgkmcnt(0)
  v_mfma_f32_32x32x16_bf16 v[128:143], v[88:91], v[104:107], v[128:143]
  ds_read_b64_tr_b16 v[64:65], v60 offset:0
  ds_read_b64_tr_b16 v[66:67], v60 offset:512
  ds_read_b64_tr_b16 v[68:69], v61 offset:0
  ds_read_b64_tr_b16 v[70:71], v61 offset:512
  v_mfma_f32_32x32x16_bf16 v[144:159], v[88:91], v[108:111], v[144:159]
  ds_read_b64_tr_b16 v[72:73], v62 offset:0
  ds_read_b64_tr_b16 v[74:75], v62 offset:512
  ds_read_b64_tr_b16 v[76:77], v63 offset:0
  ds_read_b64_tr_b16 v[78:79], v63 offset:512
  v_mfma_f32_32x32x16_bf16 v[160:175], v[92:95], v[104:107], v[160:175]
  ds_read_b128 v[80:83], v56 offset:8192
  ds_read_b128 v[84:87], v56 offset:9216
  v_mfma_f32_32x32x16_bf16 v[176:191], v[92:95], v[108:111], v[176:191]
  v_mfma_f32_32x32x16_bf16 v[192:207], v[96:99], v[104:107], v[192:207]
  s_waitcnt lgkmcnt(2)
  s_add_u32 m0, s10, 0
  s_nop 0
  buffer_load_dwordx4 v1, s[56:59], s13 offen lds
  v_mfma_f32_32x32x16_bf16 v[208:223], v[96:99], v[108:111], v[208:223]
  s_add_u32 m0, s10, 1024
  s_add_u32 s11, s13, s79
  buffer_load_dwordx4 v1, s[56:59], s11 offen lds
  v_mfma_f32_32x32x16_bf16 v[224:239], v[100:103], v[104:107], v[224:239]
  s_add_u32 m0, s10, 2048
  s_nop 0
  buffer_load_dwordx4 v15, s[60:63], s13 offen lds
  v_mfma_f32_32x32x16_bf16 v[240:255], v[100:103], v[108:111], v[240:255]
  s_add_u32 m0, s10, 3072
  s_add_u32 s11, s13, s79
  buffer_load_dwordx4 v15, s[60:63], s11 offen lds
  s_add_u32 s13, s13, s80
  v_add_u32 v56, 8192, v56
  v_add_u32 v57, 8192, v57
  v_add_u32 v58, 8192, v58
  v_add_u32 v59, 8192, v59
  s_cmp_lg_u32 s8, 3
  s_cbranch_scc1 f1_nomid
  v_mov_b32 v12, 162856
  v_mov_b32 v13, 1
  ds_write_b32 v12, v13
f1_nomid:
  s_sub_u32 s8, s8, 1
  s_cmp_lg_u32 s8, 0
  s_cbranch_scc1 f1_loop
  s_setprio 2
  s_waitcnt lgkmcnt(0)
  v_mov_b32 v12, 162816
  v_mov_b32 v13, 1
  s_mov_b64 exec, 1
  ds_add_u32 v12, v13
  s_mov_b64 exec, -1
  s_cmp_lt_u32 s6, 27
  s_cbranch_scc1 f1_epi
  s_setprio 3
  v_lshlrev_b32 v12, 4, v0
  s_sub_u32 s8, s6, 27
  s_lshl_b32 s7, s8, 13
  s_mul_i32 s8, s4, 81920
  s_add_u32 s7, s7, s8
  s_add_u32 s7, s7, 12582912
  s_add_u32 s8, s7, 4096
  s_add_u32 s82, s7, 40960
  s_add_u32 s83, s8, 40960
  v_cvt_pk_bf16_f32 v16, v128, v129
  v_cvt_pk_bf16_f32 v17, v130, v131
  v_cvt_pk_bf16_f32 v18, v136, v137
  v_cvt_pk_bf16_f32 v19, v138, v139
  buffer_store_dwordx4 v[16:19], v12, s[72:75], s7 offen offset:0 sc1
  v_cvt_pk_bf16_f32 v20, v132, v133
  v_cvt_pk_bf16_f32 v21, v134, v135
  v_cvt_pk_bf16_f32 v22, v140, v141
  v_cvt_pk_bf16_f32 v23, v142, v143
  buffer_store_dwordx4 v[20:23], v12, s[72:75], s8 offen offset:0 sc1
  v_cvt_pk_bf16_f32 v24, v144, v145
  v_cvt_pk_bf16_f32 v25, v146, v147
  v_cvt_pk_bf16_f32 v26, v152, v153
  v_cvt_pk_bf16_f32 v27, v154, v155
  buffer_store_dwordx4 v[24:27], v12, s[72:75], s82 offen offset:0 sc1
  v_cvt_pk_bf16_f32 v28, v148, v149
  v_cvt_pk_bf16_f32 v29, v150, v151
  v_cvt_pk_bf16_f32 v30, v156, v157
  v_cvt_pk_bf16_f32 v31, v158, v159
  buffer_store_dwordx4 v[28:31], v12, s[72:75], s83 offen offset:0 sc1
  v_cvt_pk_bf16_f32 v32, v160, v161
  v_cvt_pk_bf16_f32 v33, v162, v163
  v_cvt_pk_bf16_f32 v34, v168, v169
  v_cvt_pk_bf16_f32 v35, v170, v171
  buffer_store_dwordx4 v[32:35], v12, s[72:75], s7 offen offset:1024 sc1
  v_cvt_pk_bf16_f32 v36, v164, v165
  v_cvt_pk_bf16_f32 v37, v166, v167
  v_cvt_pk_bf16_f32 v38, v172, v173
  v_cvt_pk_bf16_f32 v39, v174, v175
  buffer_store_dwordx4 v[36:39], v12, s[72:75], s8 offen offset:1024 sc1
  v_cvt_pk_bf16_f32 v40, v176, v177
  v_cvt_pk_bf16_f32 v41, v178, v179
  v_cvt_pk_bf16_f32 v42, v184, v185
  v_cvt_pk_bf16_f32 v43, v186, v187
  buffer_store_dwordx4 v[40:43], v12, s[72:75], s82 offen offset:1024 sc1
  v_cvt_pk_bf16_f32 v44, v180, v181
  v_cvt_pk_bf16_f32 v45, v182, v183
  v_cvt_pk_bf16_f32 v46, v188, v189
  v_cvt_pk_bf16_f32 v47, v190, v191
  buffer_store_dwordx4 v[44:47], v12, s[72:75], s83 offen offset:1024 sc1
  v_cvt_pk_bf16_f32 v16, v192, v193
  v_cvt_pk_bf16_f32 v17, v194, v195
  v_cvt_pk_bf16_f32 v18, v200, v201
  v_cvt_pk_bf16_f32 v19, v202, v203
  buffer_store_dwordx4 v[16:19], v12, s[72:75], s7 offen offset:2048 sc1
  v_cvt_pk_bf16_f32 v20, v196, v197
  v_cvt_pk_bf16_f32 v21, v198, v199
  v_cvt_pk_bf16_f32 v22, v204, v205
  v_cvt_pk_bf16_f32 v23, v206, v207
  buffer_store_dwordx4 v[20:23], v12, s[72:75], s8 offen offset:2048 sc1
  v_cvt_pk_bf16_f32 v24, v208, v209
  v_cvt_pk_bf16_f32 v25, v210, v211
  v_cvt_pk_bf16_f32 v26, v216, v217
  v_cvt_pk_bf16_f32 v27, v218, v219
  buffer_store_dwordx4 v[24:27], v12, s[72:75], s82 offen offset:2048 sc1
  v_cvt_pk_bf16_f32 v28, v212, v213
  v_cvt_pk_bf16_f32 v29, v214, v215
  v_cvt_pk_bf16_f32 v30, v220, v221
  v_cvt_pk_bf16_f32 v31, v222, v223
  buffer_store_dwordx4 v[28:31], v12, s[72:75], s83 offen offset:2048 sc1
  v_cvt_pk_bf16_f32 v32, v224, v225
  v_cvt_pk_bf16_f32 v33, v226, v227
  v_cvt_pk_bf16_f32 v34, v232, v233
  v_cvt_pk_bf16_f32 v35, v234, v235
  buffer_store_dwordx4 v[32:35], v12, s[72:75], s7 offen offset:3072 sc1
  v_cvt_pk_bf16_f32 v36, v228, v229
  v_cvt_pk_bf16_f32 v37, v230, v231
  v_cvt_pk_bf16_f32 v38, v236, v237
  v_cvt_pk_bf16_f32 v39, v238, v239
  buffer_store_dwordx4 v[36:39], v12, s[72:75], s8 offen offset:3072 sc1
  v_cvt_pk_bf16_f32 v40, v240, v241
  v_cvt_pk_bf16_f32 v41, v242, v243
  v_cvt_pk_bf16_f32 v42, v248, v249
  v_cvt_pk_bf16_f32 v43, v250, v251
  buffer_store_dwordx4 v[40:43], v12, s[72:75], s82 offen offset:3072 sc1
  v_cvt_pk_bf16_f32 v44, v244, v245
  v_cvt_pk_bf16_f32 v45, v246, v247
  v_cvt_pk_bf16_f32 v46, v252, v253
  v_cvt_pk_bf16_f32 v47, v254, v255
  buffer_store_dwordx4 v[44:47], v12, s[72:75], s83 offen offset:3072 sc1
  s_lshl_b32 s7, s4, 15
  s_sub_u32 s8, s6, 27
  s_mul_i32 s82, s8, 32
  s_mul_i32 s82, s82, 0x3334
  s_lshr_b32 s82, s82, 16
  s_lshl_b32 s8, s8, 7
  s_add_u32 s7, s7, s8
  s_add_u32 s7, s7, 17825792
  v_add_u32 v12, s82, v0
  v_min_u32 v12, 31, v12
  v_lshlrev_b32 v12, 10, v12
  v_mov_b32 v13, s15
  s_waitcnt vmcnt(0)
  s_mov_b64 exec, 0xff
  buffer_store_dword v13, v12, s[72:75], s7 offen sc1
  s_mov_b64 exec, -1
  s_setprio 2
  s_branch f1_epi_skip
f1_epi:
  s_nop 3
  v_mul_f32 v16, 0xbfb8aa3b, v128
  v_mul_f32 v17, 0xbfb8aa3b, v129
  v_mul_f32 v18, 0xbfb8aa3b, v130
  v_mul_f32 v19, 0xbfb8aa3b, v131
  v_mul_f32 v20, 0xbfb8aa3b, v136
  v_mul_f32 v21, 0xbfb8aa3b, v137
  v_mul_f32 v22, 0xbfb8aa3b, v138
  v_mul_f32 v23, 0xbfb8aa3b, v139
  v_exp_f32 v16, v16
  v_exp_f32 v17, v17
  v_exp_f32 v18, v18
  v_exp_f32 v19, v19
  v_exp_f32 v20, v20
  v_exp_f32 v21, v21
  v_exp_f32 v22, v22
  v_exp_f32 v23, v23
  v_add_f32 v16, 1.0, v16
  v_add_f32 v17, 1.0, v17
  v_add_f32 v18, 1.0, v18
  v_add_f32 v19, 1.0, v19
  v_add_f32 v20, 1.0, v20
  v_add_f32 v21, 1.0, v21
  v_add_f32 v22, 1.0, v22
  v_add_f32 v23, 1.0, v23
  v_rcp_f32 v16, v16
  v_rcp_f32 v17, v17
  v_rcp_f32 v18, v18
  v_rcp_f32 v19, v19
  v_rcp_f32 v20, v20
  v_rcp_f32 v21, v21
  v_rcp_f32 v22, v22
  v_rcp_f32 v23, v23
  v_mul_f32 v128, v128, v132
  v_mul_f32 v129, v129, v133
  v_mul_f32 v130, v130, v134
  v_mul_f32 v131, v131, v135
  v_mul_f32 v136, v136, v140
  v_mul_f32 v137, v137, v141
  v_mul_f32 v138, v138, v142
  v_mul_f32 v139, v139, v143
  v_mul_f32 v16, v16, v128
  v_mul_f32 v17, v17, v129
  v_mul_f32 v18, v18, v130
  v_mul_f32 v19, v19, v131
  v_mul_f32 v20, v20, v136
  v_mul_f32 v21, v21, v137
  v_mul_f32 v22, v22, v138
  v_mul_f32 v23, v23, v139
  v_cvt_pk_bf16_f32 v24, v16, v17
  v_cvt_pk_bf16_f32 v25, v18, v19
  v_cvt_pk_bf16_f32 v26, v20, v21
  v_cvt_pk_bf16_f32 v27, v22, v23
  v_mul_f32 v16, 0xbfb8aa3b, v144
  v_mul_f32 v17, 0xbfb8aa3b, v145
  v_mul_f32 v18, 0xbfb8aa3b, v146
  v_mul_f32 v19, 0xbfb8aa3b, v147
  v_mul_f32 v20, 0xbfb8aa3b, v152
  v_mul_f32 v21, 0xbfb8aa3b, v153
  v_mul_f32 v22, 0xbfb8aa3b, v154
  v_mul_f32 v23, 0xbfb8aa3b, v155
  v_exp_f32 v16, v16
  v_exp_f32 v17, v17
  v_exp_f32 v18, v18
  v_exp_f32 v19, v19
  v_exp_f32 v20, v20
  v_exp_f32 v21, v21
  v_exp_f32 v22, v22
  v_exp_f32 v23, v23
  v_add_f32 v16, 1.0, v16
  v_add_f32 v17, 1.0, v17
  v_add_f32 v18, 1.0, v18
  v_add_f32 v19, 1.0, v19
  v_add_f32 v20, 1.0, v20
  v_add_f32 v21, 1.0, v21
  v_add_f32 v22, 1.0, v22
  v_add_f32 v23, 1.0, v23
  v_rcp_f32 v16, v16
  v_rcp_f32 v17, v17
  v_rcp_f32 v18, v18
  v_rcp_f32 v19, v19
  v_rcp_f32 v20, v20
  v_rcp_f32 v21, v21
  v_rcp_f32 v22, v22
  v_rcp_f32 v23, v23
  v_mul_f32 v144, v144, v148
  v_mul_f32 v145, v145, v149
  v_mul_f32 v146, v146, v150
  v_mul_f32 v147, v147, v151
  v_mul_f32 v152, v152, v156
  v_mul_f32 v153, v153, v157
  v_mul_f32 v154, v154, v158
  v_mul_f32 v155, v155, v159
  v_mul_f32 v16, v16, v144
  v_mul_f32 v17, v17, v145
  v_mul_f32 v18, v18, v146
  v_mul_f32 v19, v19, v147
  v_mul_f32 v20, v20, v152
  v_mul_f32 v21, v21, v153
  v_mul_f32 v22, v22, v154
  v_mul_f32 v23, v23, v155
  v_cvt_pk_bf16_f32 v28, v16, v17
  v_cvt_pk_bf16_f32 v29, v18, v19
  v_cvt_pk_bf16_f32 v30, v20, v21
  v_cvt_pk_bf16_f32 v31, v22, v23
  v_mul_f32 v16, 0xbfb8aa3b, v160
  v_mul_f32 v17, 0xbfb8aa3b, v161
  v_mul_f32 v18, 0xbfb8aa3b, v162
  v_mul_f32 v19, 0xbfb8aa3b, v163
  v_mul_f32 v20, 0xbfb8aa3b, v168
  v_mul_f32 v21, 0xbfb8aa3b, v169
  v_mul_f32 v22, 0xbfb8aa3b, v170
  v_mul_f32 v23, 0xbfb8aa3b, v171
  v_exp_f32 v16, v16
  v_exp_f32 v17, v17
  v_exp_f32 v18, v18
  v_exp_f32 v19, v19
  v_exp_f32 v20, v20
  v_exp_f32 v21, v21
  v_exp_f32 v22, v22
  v_exp_f32 v23, v23
  v_add_f32 v16, 1.0, v16
  v_add_f32 v17, 1.0, v17
  v_add_f32 v18, 1.0, v18
  v_add_f32 v19, 1.0, v19
  v_add_f32 v20, 1.0, v20
  v_add_f32 v21, 1.0, v21
  v_add_f32 v22, 1.0, v22
  v_add_f32 v23, 1.0, v23
  v_rcp_f32 v16, v16
  v_rcp_f32 v17, v17
  v_rcp_f32 v18, v18
  v_rcp_f32 v19, v19
  v_rcp_f32 v20, v20
  v_rcp_f32 v21, v21
  v_rcp_f32 v22, v22
  v_rcp_f32 v23, v23
  v_mul_f32 v160, v160, v164
  v_mul_f32 v161, v161, v165
  v_mul_f32 v162, v162, v166
  v_mul_f32 v163, v163, v167
  v_mul_f32 v168, v168, v172
  v_mul_f32 v169, v169, v173
  v_mul_f32 v170, v170, v174
  v_mul_f32 v171, v171, v175
  v_mul_f32 v16, v16, v160
  v_mul_f32 v17, v17, v161
  v_mul_f32 v18, v18, v162
  v_mul_f32 v19, v19, v163
  v_mul_f32 v20, v20, v168
  v_mul_f32 v21, v21, v169
  v_mul_f32 v22, v22, v170
  v_mul_f32 v23, v23, v171
  v_cvt_pk_bf16_f32 v32, v16, v17
  v_cvt_pk_bf16_f32 v33, v18, v19
  v_cvt_pk_bf16_f32 v34, v20, v21
  v_cvt_pk_bf16_f32 v35, v22, v23
  v_mul_f32 v16, 0xbfb8aa3b, v176
  v_mul_f32 v17, 0xbfb8aa3b, v177
  v_mul_f32 v18, 0xbfb8aa3b, v178
  v_mul_f32 v19, 0xbfb8aa3b, v179
  v_mul_f32 v20, 0xbfb8aa3b, v184
  v_mul_f32 v21, 0xbfb8aa3b, v185
  v_mul_f32 v22, 0xbfb8aa3b, v186
  v_mul_f32 v23, 0xbfb8aa3b, v187
  v_exp_f32 v16, v16
  v_exp_f32 v17, v17
  v_exp_f32 v18, v18
  v_exp_f32 v19, v19
  v_exp_f32 v20, v20
  v_exp_f32 v21, v21
  v_exp_f32 v22, v22
  v_exp_f32 v23, v23
  v_add_f32 v16, 1.0, v16
  v_add_f32 v17, 1.0, v17
  v_add_f32 v18, 1.0, v18
  v_add_f32 v19, 1.0, v19
  v_add_f32 v20, 1.0, v20
  v_add_f32 v21, 1.0, v21
  v_add_f32 v22, 1.0, v22
  v_add_f32 v23, 1.0, v23
  v_rcp_f32 v16, v16
  v_rcp_f32 v17, v17
  v_rcp_f32 v18, v18
  v_rcp_f32 v19, v19
  v_rcp_f32 v20, v20
  v_rcp_f32 v21, v21
  v_rcp_f32 v22, v22
  v_rcp_f32 v23, v23
  v_mul_f32 v176, v176, v180
  v_mul_f32 v177, v177, v181
  v_mul_f32 v178, v178, v182
  v_mul_f32 v179, v179, v183
  v_mul_f32 v184, v184, v188
  v_mul_f32 v185, v185, v189
  v_mul_f32 v186, v186, v190
  v_mul_f32 v187, v187, v191
  v_mul_f32 v16, v16, v176
  v_mul_f32 v17, v17, v177
  v_mul_f32 v18, v18, v178
  v_mul_f32 v19, v19, v179
  v_mul_f32 v20, v20, v184
  v_mul_f32 v21, v21, v185
  v_mul_f32 v22, v22, v186
  v_mul_f32 v23, v23, v187
  v_cvt_pk_bf16_f32 v36, v16, v17
  v_cvt_pk_bf16_f32 v37, v18, v19
  v_cvt_pk_bf16_f32 v38, v20, v21
  v_cvt_pk_bf16_f32 v39, v22, v23
  v_mul_f32 v16, 0xbfb8aa3b, v192
  v_mul_f32 v17, 0xbfb8aa3b, v193
  v_mul_f32 v18, 0xbfb8aa3b, v194
  v_mul_f32 v19, 0xbfb8aa3b, v195
  v_mul_f32 v20, 0xbfb8aa3b, v200
  v_mul_f32 v21, 0xbfb8aa3b, v201
  v_mul_f32 v22, 0xbfb8aa3b, v202
  v_mul_f32 v23, 0xbfb8aa3b, v203
  v_exp_f32 v16, v16
  v_exp_f32 v17, v17
  v_exp_f32 v18, v18
  v_exp_f32 v19, v19
  v_exp_f32 v20, v20
  v_exp_f32 v21, v21
  v_exp_f32 v22, v22
  v_exp_f32 v23, v23
  v_add_f32 v16, 1.0, v16
  v_add_f32 v17, 1.0, v17
  v_add_f32 v18, 1.0, v18
  v_add_f32 v19, 1.0, v19
  v_add_f32 v20, 1.0, v20
  v_add_f32 v21, 1.0, v21
  v_add_f32 v22, 1.0, v22
  v_add_f32 v23, 1.0, v23
  v_rcp_f32 v16, v16
  v_rcp_f32 v17, v17
  v_rcp_f32 v18, v18
  v_rcp_f32 v19, v19
  v_rcp_f32 v20, v20
  v_rcp_f32 v21, v21
  v_rcp_f32 v22, v22
  v_rcp_f32 v23, v23
  v_mul_f32 v192, v192, v196
  v_mul_f32 v193, v193, v197
  v_mul_f32 v194, v194, v198
  v_mul_f32 v195, v195, v199
  v_mul_f32 v200, v200, v204
  v_mul_f32 v201, v201, v205
  v_mul_f32 v202, v202, v206
  v_mul_f32 v203, v203, v207
  v_mul_f32 v16, v16, v192
  v_mul_f32 v17, v17, v193
  v_mul_f32 v18, v18, v194
  v_mul_f32 v19, v19, v195
  v_mul_f32 v20, v20, v200
  v_mul_f32 v21, v21, v201
  v_mul_f32 v22, v22, v202
  v_mul_f32 v23, v23, v203
  v_cvt_pk_bf16_f32 v40, v16, v17
  v_cvt_pk_bf16_f32 v41, v18, v19
  v_cvt_pk_bf16_f32 v42, v20, v21
  v_cvt_pk_bf16_f32 v43, v22, v23
  v_mul_f32 v16, 0xbfb8aa3b, v208
  v_mul_f32 v17, 0xbfb8aa3b, v209
  v_mul_f32 v18, 0xbfb8aa3b, v210
  v_mul_f32 v19, 0xbfb8aa3b, v211
  v_mul_f32 v20, 0xbfb8aa3b, v216
  v_mul_f32 v21, 0xbfb8aa3b, v217
  v_mul_f32 v22, 0xbfb8aa3b, v218
  v_mul_f32 v23, 0xbfb8aa3b, v219
  v_exp_f32 v16, v16
  v_exp_f32 v17, v17
  v_exp_f32 v18, v18
  v_exp_f32 v19, v19
  v_exp_f32 v20, v20
  v_exp_f32 v21, v21
  v_exp_f32 v22, v22
  v_exp_f32 v23, v23
  v_add_f32 v16, 1.0, v16
  v_add_f32 v17, 1.0, v17
  v_add_f32 v18, 1.0, v18
  v_add_f32 v19, 1.0, v19
  v_add_f32 v20, 1.0, v20
  v_add_f32 v21, 1.0, v21
  v_add_f32 v22, 1.0, v22
  v_add_f32 v23, 1.0, v23
  v_rcp_f32 v16, v16
  v_rcp_f32 v17, v17
  v_rcp_f32 v18, v18
  v_rcp_f32 v19, v19
  v_rcp_f32 v20, v20
  v_rcp_f32 v21, v21
  v_rcp_f32 v22, v22
  v_rcp_f32 v23, v23
  v_mul_f32 v208, v208, v212
  v_mul_f32 v209, v209, v213
  v_mul_f32 v210, v210, v214
  v_mul_f32 v211, v211, v215
  v_mul_f32 v216, v216, v220
  v_mul_f32 v217, v217, v221
  v_mul_f32 v218, v218, v222
  v_mul_f32 v219, v219, v223
  v_mul_f32 v16, v16, v208
  v_mul_f32 v17, v17, v209
  v_mul_f32 v18, v18, v210
  v_mul_f32 v19, v19, v211
  v_mul_f32 v20, v20, v216
  v_mul_f32 v21, v21, v217
  v_mul_f32 v22, v22, v218
  v_mul_f32 v23, v23, v219
  v_cvt_pk_bf16_f32 v44, v16, v17
  v_cvt_pk_bf16_f32 v45, v18, v19
  v_cvt_pk_bf16_f32 v46, v20, v21
  v_cvt_pk_bf16_f32 v47, v22, v23
  v_mul_f32 v16, 0xbfb8aa3b, v224
  v_mul_f32 v17, 0xbfb8aa3b, v225
  v_mul_f32 v18, 0xbfb8aa3b, v226
  v_mul_f32 v19, 0xbfb8aa3b, v227
  v_mul_f32 v20, 0xbfb8aa3b, v232
  v_mul_f32 v21, 0xbfb8aa3b, v233
  v_mul_f32 v22, 0xbfb8aa3b, v234
  v_mul_f32 v23, 0xbfb8aa3b, v235
  v_exp_f32 v16, v16
  v_exp_f32 v17, v17
  v_exp_f32 v18, v18
  v_exp_f32 v19, v19
  v_exp_f32 v20, v20
  v_exp_f32 v21, v21
  v_exp_f32 v22, v22
  v_exp_f32 v23, v23
  v_add_f32 v16, 1.0, v16
  v_add_f32 v17, 1.0, v17
  v_add_f32 v18, 1.0, v18
  v_add_f32 v19, 1.0, v19
  v_add_f32 v20, 1.0, v20
  v_add_f32 v21, 1.0, v21
  v_add_f32 v22, 1.0, v22
  v_add_f32 v23, 1.0, v23
  v_rcp_f32 v16, v16
  v_rcp_f32 v17, v17
  v_rcp_f32 v18, v18
  v_rcp_f32 v19, v19
  v_rcp_f32 v20, v20
  v_rcp_f32 v21, v21
  v_rcp_f32 v22, v22
  v_rcp_f32 v23, v23
  v_mul_f32 v224, v224, v228
  v_mul_f32 v225, v225, v229
  v_mul_f32 v226, v226, v230
  v_mul_f32 v227, v227, v231
  v_mul_f32 v232, v232, v236
  v_mul_f32 v233, v233, v237
  v_mul_f32 v234, v234, v238
  v_mul_f32 v235, v235, v239
  v_mul_f32 v16, v16, v224
  v_mul_f32 v17, v17, v225
  v_mul_f32 v18, v18, v226
  v_mul_f32 v19, v19, v227
  v_mul_f32 v20, v20, v232
  v_mul_f32 v21, v21, v233
  v_mul_f32 v22, v22, v234
  v_mul_f32 v23, v23, v235
  v_cvt_pk_bf16_f32 v48, v16, v17
  v_cvt_pk_bf16_f32 v49, v18, v19
  v_cvt_pk_bf16_f32 v50, v20, v21
  v_cvt_pk_bf16_f32 v51, v22, v23
  v_mul_f32 v16, 0xbfb8aa3b, v240
  v_mul_f32 v17, 0xbfb8aa3b, v241
  v_mul_f32 v18, 0xbfb8aa3b, v242
  v_mul_f32 v19, 0xbfb8aa3b, v243
  v_mul_f32 v20, 0xbfb8aa3b, v248
  v_mul_f32 v21, 0xbfb8aa3b, v249
  v_mul_f32 v22, 0xbfb8aa3b, v250
  v_mul_f32 v23, 0xbfb8aa3b, v251
  v_exp_f32 v16, v16
  v_exp_f32 v17, v17
  v_exp_f32 v18, v18
  v_exp_f32 v19, v19
  v_exp_f32 v20, v20
  v_exp_f32 v21, v21
  v_exp_f32 v22, v22
  v_exp_f32 v23, v23
  v_add_f32 v16, 1.0, v16
  v_add_f32 v17, 1.0, v17
  v_add_f32 v18, 1.0, v18
  v_add_f32 v19, 1.0, v19
  v_add_f32 v20, 1.0, v20
  v_add_f32 v21, 1.0, v21
  v_add_f32 v22, 1.0, v22
  v_add_f32 v23, 1.0, v23
  v_rcp_f32 v16, v16
  v_rcp_f32 v17, v17
  v_rcp_f32 v18, v18
  v_rcp_f32 v19, v19
  v_rcp_f32 v20, v20
  v_rcp_f32 v21, v21
  v_rcp_f32 v22, v22
  v_rcp_f32 v23, v23
  v_mul_f32 v240, v240, v244
  v_mul_f32 v241, v241, v245
  v_mul_f32 v242, v242, v246
  v_mul_f32 v243, v243, v247
  v_mul_f32 v248, v248, v252
  v_mul_f32 v249, v249, v253
  v_mul_f32 v250, v250, v254
  v_mul_f32 v251, v251, v255
  v_mul_f32 v16, v16, v240
  v_mul_f32 v17, v17, v241
  v_mul_f32 v18, v18, v242
  v_mul_f32 v19, v19, v243
  v_mul_f32 v20, v20, v248
  v_mul_f32 v21, v21, v249
  v_mul_f32 v22, v22, v250
  v_mul_f32 v23, v23, v251
  v_cvt_pk_bf16_f32 v52, v16, v17
  v_cvt_pk_bf16_f32 v53, v18, v19
  v_cvt_pk_bf16_f32 v54, v20, v21
  v_cvt_pk_bf16_f32 v55, v22, v23
f1_epi_skip:
  s_and_b32 s76, s5, 1
  s_lshr_b32 s77, s5, 1
  s_mul_i32 s77, s77, 320
  s_lshl_b32 s8, s76, 7
  s_add_u32 s77, s77, s8
  v_add_u32 v12, 0, v0
  v_mul_u32_u24 v13, 0xaab, v12
  v_lshrrev_b32 v13, 15, v13
  v_mul_u32_u24 v14, 12, v13
  v_sub_u32 v14, v12, v14
  v_mul_u32_u24 v13, 1280, v13
  v_lshl_add_u32 v13, v14, 4, v13
  v_add_u32 v2, s77, v13
  v_add_u32 v12, 64, v0
  v_mul_u32_u24 v13, 0xaab, v12
  v_lshrrev_b32 v13, 15, v13
  v_mul_u32_u24 v14, 12, v13
  v_sub_u32 v14, v12, v14
  v_mul_u32_u24 v13, 1280, v13
  v_lshl_add_u32 v13, v14, 4, v13
  v_add_u32 v3, s77, v13
  v_add_u32 v12, 128, v0
  v_mul_u32_u24 v13, 0xaab, v12
  v_lshrrev_b32 v13, 15, v13
  v_mul_u32_u24 v14, 12, v13
  v_sub_u32 v14, v12, v14
  v_mul_u32_u24 v13, 1280, v13
  v_lshl_add_u32 v13, v14, 4, v13
  v_add_u32 v4, s77, v13
  v_add_u32 v12, 192, v0
  v_mul_u32_u24 v13, 0xaab, v12
  v_lshrrev_b32 v13, 15, v13
  v_mul_u32_u24 v14, 12, v13
  v_sub_u32 v14, v12, v14
  v_mul_u32_u24 v13, 1280, v13
  v_lshl_add_u32 v13, v14, 4, v13
  v_add_u32 v5, s77, v13
  v_cmp_lt_u32 vcc, 47, v0
  v_mov_b32 v12, 2130706432
  s_mul_i32 s78, s9, 28
  v_cndmask_b32 v5, v5, v12, vcc
  s_mul_i32 s11, s78, 20480
  s_add_u32 s7, s11, 573440
  s_min_u32 s66, s7, 2211840
  s_lshl_b32 s84, s9, 14
  s_lshl_b32 s79, s76, 6
  s_add_u32 s80, s79, 64
  s_cmp_eq_u32 s76, 0
  s_cselect_b32 s81, 128, 0
  v_bfe_u32 v12, v0, 2, 2
  v_mul_u32_u24 v12, 192, v12
  v_bfe_u32 v13, v0, 4, 1
  v_bfe_u32 v14, v0, 1, 1
  v_lshl_add_u32 v13, v13, 1, v14
  v_add_u32 v13, s9, v13
  v_and_b32 v13, 3, v13
  v_lshl_add_u32 v12, v13, 4, v12
  v_and_b32 v13, 1, v0
  v_lshl_add_u32 v12, v13, 3, v12
  v_add_u32 v11, s10, v12
  v_lshrrev_b32 v13, 5, v0
  v_mul_u32_u24 v14, 1536, v13
  v_add3_u32 v6, v11, v14, s79
  v_add3_u32 v7, v11, v14, s80
  v_add3_u32 v8, v11, v14, s81
  v_add_u32 v11, s84, v12
  v_mul_u32_u24 v14, 768, v13
  v_lshlrev_b32 v15, 13, v13
  v_add3_u32 v250, v11, v14, s79
  v_add3_u32 v253, v11, v15, s79
  v_add3_u32 v251, v11, v14, s80
  v_add3_u32 v254, v11, v15, s80
  v_add3_u32 v252, v11, v14, s81
  v_add3_u32 v255, v11, v15, s81
  v_lshlrev_b32 v11, 4, v0
  s_lshl_b32 s7, s76, 10
  v_add_u32 v9, s7, v11
  s_xor_b32 s7, s7, 1024
  v_add_u32 v10, s7, v11
  v_mov_b32 v80, 0
  v_mov_b32 v81, 0
  v_mov_b32 v82, 0
  v_mov_b32 v83, 0
  v_mov_b32 v84, 0
  v_mov_b32 v85, 0
  v_mov_b32 v86, 0
  v_mov_b32 v87, 0
  v_mov_b32 v88, 0
  v_mov_b32 v89, 0
  v_mov_b32 v90, 0
  v_mov_b32 v91, 0
  v_mov_b32 v92, 0
  v_mov_b32 v93, 0
  v_mov_b32 v94, 0
  v_mov_b32 v95, 0
  v_mov_b32 v96, 0
  v_mov_b32 v97, 0
  v_mov_b32 v98, 0
  v_mov_b32 v99, 0
  v_mov_b32 v100, 0
  v_mov_b32 v101, 0
  v_mov_b32 v102, 0
  v_mov_b32 v103, 0
  v_mov_b32 v104, 0
  v_mov_b32 v105, 0
  v_mov_b32 v106, 0
  v_mov_b32 v107, 0
  v_mov_b32 v108, 0
  v_mov_b32 v109, 0
  v_mov_b32 v110, 0
  v_mov_b32 v111, 0
  v_mov_b32 v112, 0
  v_mov_b32 v113, 0
  v_mov_b32 v114, 0
  v_mov_b32 v115, 0
  v_mov_b32 v116, 0
  v_mov_b32 v117, 0
  v_mov_b32 v118, 0
  v_mov_b32 v119, 0
  v_mov_b32 v120, 0
  v_mov_b32 v121, 0
  v_mov_b32 v122, 0
  v_mov_b32 v123, 0
  v_mov_b32 v124, 0
  v_mov_b32 v125, 0
  v_mov_b32 v126, 0
  v_mov_b32 v127, 0
  v_mov_b32 v128, 0
  v_mov_b32 v129, 0
  v_mov_b32 v130, 0
  v_mov_b32 v131, 0
  v_mov_b32 v132, 0
  v_mov_b32 v133, 0
  v_mov_b32 v134, 0
  v_mov_b32 v135, 0
  v_mov_b32 v136, 0
  v_mov_b32 v137, 0
  v_mov_b32 v138, 0
  v_mov_b32 v139, 0
  v_mov_b32 v140, 0
  v_mov_b32 v141, 0
  v_mov_b32 v142, 0
  v_mov_b32 v143, 0
  v_mov_b32 v144, 0
  v_mov_b32 v145, 0
  v_mov_b32 v146, 0
  v_mov_b32 v147, 0
  v_mov_b32 v148, 0
  v_mov_b32 v149, 0
  v_mov_b32 v150, 0
  v_mov_b32 v151, 0
  v_mov_b32 v152, 0
  v_mov_b32 v153, 0
  v_mov_b32 v154, 0
  v_mov_b32 v155, 0
  v_mov_b32 v156, 0
  v_mov_b32 v157, 0
  v_mov_b32 v158, 0
  v_mov_b32 v159, 0
  s_cmp_eq_u32 s9, 3
  s_cselect_b32 s7, 5, 6
  v_min_u32 v15, s7, v0
  v_lshlrev_b32 v15, 7, v15
  s_lshl_b32 s83, s4, 3
  s_add_u32 s83, s83, s5
  s_lshl_b32 s83, s83, 2
  s_add_u32 s83, s83, s9
  s_lshl_b32 s83, s83, 10
  s_add_u32 s83, s83, 15728640
  s_mul_i32 s12, s4, 221184
  s_add_u32 s12, s12, 1048576
  s_lshl_b32 s8, s78, 11
  s_add_u32 s82, s12, s8
  s_lshl_b32 s8, s6, 13
  s_add_u32 s12, s12, s8
  s_mov_b32 s44, s38
  s_mov_b32 s45, s39
  s_cmp_eq_u32 s9, 3
  s_cselect_b32 s8, 24, 28
  s_lshl_b32 s8, s8, 11
  s_add_u32 s46, s82, s8
  s_mul_i32 s8, s6, 37
  s_lshr_b32 s8, s8, 8
  s_mul_i32 s7, s8, 7
  s_sub_u32 s7, s6, s7
  s_lshl_b32 s8, s8, 10
  s_lshl_b32 s7, s7, 7
  s_lshl_b32 s13, s4, 15
  s_add_u32 s13, s13, s8
  s_add_u32 s13, s13, s7
  s_add_u32 s13, s13, 15728640
  v_lshlrev_b32 v1, 12, v0
  v_mov_b32 v14, s15
  s_setprio 0
  v_mov_b32 v12, 162816
  s_mov_b32 s8, 0x40000
lw_25:
  ds_read_b32 v13, v12
  s_waitcnt lgkmcnt(0)
  v_readfirstlane_b32 s7, v13
  s_cmp_ge_u32 s7, 5
  s_cbranch_scc1 lwd_26
  s_sleep 4
  s_sub_u32 s8, s8, 1
  s_cmp_lg_u32 s8, 0
  s_cbranch_scc1 lw_25
lwd_26:
  s_waitcnt vmcnt(0)
  v_mov_b32 v12, 162844
  s_mov_b32 s8, 0x40000
lw_27:
  ds_read_b32 v13, v12
  s_waitcnt lgkmcnt(0)
  v_readfirstlane_b32 s7, v13
  s_cmp_ge_u32 s7, 4
  s_cbranch_scc1 lwd_28
  s_sleep 4
  s_sub_u32 s8, s8, 1
  s_cmp_lg_u32 s8, 0
  s_cbranch_scc1 lw_27
lwd_28:
  s_cmp_ge_u32 s6, 27
  s_cbranch_scc1 h_st_skip
  buffer_store_dwordx4 v[24:27], v11, s[72:75], s12 offen offset:0 sc1
  buffer_store_dwordx4 v[28:31], v11, s[72:75], s12 offen offset:1024 sc1
  buffer_store_dwordx4 v[32:35], v11, s[72:75], s12 offen offset:2048 sc1
  buffer_store_dwordx4 v[36:39], v11, s[72:75], s12 offen offset:3072 sc1
  s_add_u32 s12, s12, 4096
  buffer_store_dwordx4 v[40:43], v11, s[72:75], s12 offen offset:0 sc1
  buffer_store_dwordx4 v[44:47], v11, s[72:75], s12 offen offset:1024 sc1
  buffer_store_dwordx4 v[48:51], v11, s[72:75], s12 offen offset:2048 sc1
  buffer_store_dwordx4 v[52:55], v11, s[72:75], s12 offen offset:3072 sc1
h_st_skip:
  s_add_u32 m0, s10, 0
  s_nop 0
  buffer_load_dwordx4 v2, s[64:67], s11 offen lds
  s_add_u32 m0, s10, 1024
  s_nop 0
  buffer_load_dwordx4 v3, s[64:67], s11 offen lds
  s_add_u32 m0, s10, 2048
  s_nop 0
  buffer_load_dwordx4 v4, s[64:67], s11 offen lds
  s_add_u32 s11, s11, 20480
  s_add_u32 m0, s10, 4096
  s_nop 0
  buffer_load_dwordx4 v2, s[64:67], s11 offen lds
  s_add_u32 m0, s10, 5120
  s_nop 0
  buffer_load_dwordx4 v3, s[64:67], s11 offen lds
  s_add_u32 m0, s10, 6144
  s_nop 0
  buffer_load_dwordx4 v4, s[64:67], s11 offen lds
  s_add_u32 s11, s11, 20480
  s_add_u32 m0, s10, 8192
  s_nop 0
  buffer_load_dwordx4 v2, s[64:67], s11 offen lds
  s_add_u32 m0, s10, 9216
  s_nop 0
  buffer_load_dwordx4 v3, s[64:67], s11 offen lds
  s_add_u32 m0, s10, 10240
  s_nop 0
  buffer_load_dwordx4 v4, s[64:67], s11 offen lds
  s_add_u32 s11, s11, 20480
  s_add_u32 m0, s10, 12288
  s_nop 0
  buffer_load_dwordx4 v2, s[64:67], s11 offen lds
  s_add_u32 m0, s10, 13312
  s_nop 0
  buffer_load_dwordx4 v3, s[64:67], s11 offen lds
  s_add_u32 m0, s10, 14336
  s_nop 0
  buffer_load_dwordx4 v4, s[64:67], s11 offen lds
  s_add_u32 s11, s11, 20480
  s_cmp_ge_u32 s6, 27
  s_cbranch_scc1 h_fl_skip
  s_waitcnt vmcnt(12)
  s_mov_b64 exec, 0xff
  buffer_store_dword v14, v1, s[72:75], s13 offen sc1
  s_mov_b64 exec, -1
h_fl_skip:
  s_mul_i32 s7, s9, 102400
  s_add_u32 s7, s7, 0
  s_add_u32 m0, s84, 0
  s_nop 0
  buffer_load_dwordx4 v2, s[52:55], s7 offen lds
  s_add_u32 m0, s84, 1024
  s_nop 0
  buffer_load_dwordx4 v3, s[52:55], s7 offen lds
  s_add_u32 m0, s84, 2048
  s_nop 0
  buffer_load_dwordx4 v4, s[52:55], s7 offen lds
  s_add_u32 m0, s84, 3072
  s_nop 0
  buffer_load_dwordx4 v5, s[52:55], s7 offen lds
  s_mul_i32 s7, s9, 102400
  s_add_u32 s7, s7, 25600
  s_add_u32 m0, s84, 4096
  s_nop 0
  buffer_load_dwordx4 v2, s[52:55], s7 offen lds
  s_add_u32 m0, s84, 5120
  s_nop 0
  buffer_load_dwordx4 v3, s[52:55], s7 offen lds
  s_add_u32 m0, s84, 6144
  s_nop 0
  buffer_load_dwordx4 v4, s[52:55], s7 offen lds
  s_add_u32 m0, s84, 7168
  s_nop 0
  buffer_load_dwordx4 v5, s[52:55], s7 offen lds
  s_mul_i32 s7, s9, 102400
  s_add_u32 s7, s7, 51200
  s_add_u32 m0, s84, 8192
  s_nop 0
  buffer_load_dwordx4 v2, s[52:55], s7 offen lds
  s_add_u32 m0, s84, 9216
  s_nop 0
  buffer_load_dwordx4 v3, s[52:55], s7 offen lds
  s_add_u32 m0, s84, 10240
  s_nop 0
  buffer_load_dwordx4 v4, s[52:55], s7 offen lds
  s_add_u32 m0, s84, 11264
  s_nop 0
  buffer_load_dwordx4 v5, s[52:55], s7 offen lds
  s_mul_i32 s7, s9, 102400
  s_add_u32 s7, s7, 76800
  s_add_u32 m0, s84, 12288
  s_nop 0
  buffer_load_dwordx4 v2, s[52:55], s7 offen lds
  s_add_u32 m0, s84, 13312
  s_nop 0
  buffer_load_dwordx4 v3, s[52:55], s7 offen lds
  s_add_u32 m0, s84, 14336
  s_nop 0
  buffer_load_dwordx4 v4, s[52:55], s7 offen lds
  s_add_u32 m0, s84, 15360
  s_nop 0
  buffer_load_dwordx4 v5, s[52:55], s7 offen lds
  s_waitcnt vmcnt(0)
  ds_read_b64_tr_b16 v[160:161], v250 offset:0
  ds_read_b64_tr_b16 v[162:163], v250 offset:1536
  ds_read_b64_tr_b16 v[164:165], v251 offset:0
  ds_read_b64_tr_b16 v[166:167], v251 offset:1536
  ds_read_b64_tr_b16 v[168:169], v252 offset:0
  ds_read_b64_tr_b16 v[170:171], v252 offset:1536
  ds_read_b64_tr_b16 v[172:173], v250 offset:4096
  ds_read_b64_tr_b16 v[174:175], v250 offset:5632
  ds_read_b64_tr_b16 v[176:177], v251 offset:4096
  ds_read_b64_tr_b16 v[178:179], v251 offset:5632
  ds_read_b64_tr_b16 v[180:181], v252 offset:4096
  ds_read_b64_tr_b16 v[182:183], v252 offset:5632
  ds_read_b64_tr_b16 v[184:185], v250 offset:8192
  ds_read_b64_tr_b16 v[186:187], v250 offset:9728
  ds_read_b64_tr_b16 v[188:189], v251 offset:8192
  ds_read_b64_tr_b16 v[190:191], v251 offset:9728
  ds_read_b64_tr_b16 v[192:193], v252 offset:8192
  ds_read_b64_tr_b16 v[194:195], v252 offset:9728
  ds_read_b64_tr_b16 v[196:197], v250 offset:12288
  ds_read_b64_tr_b16 v[198:199], v250 offset:13824
  ds_read_b64_tr_b16 v[200:201], v251 offset:12288
  ds_read_b64_tr_b16 v[202:203], v251 offset:13824
  ds_read_b64_tr_b16 v[204:205], v252 offset:12288
  ds_read_b64_tr_b16 v[206:207], v252 offset:13824
  ds_read_b64_tr_b16 v[208:209], v253 offset:3072
  ds_read_b64_tr_b16 v[210:211], v253 offset:7168
  ds_read_b64_tr_b16 v[212:213], v254 offset:3072
  ds_read_b64_tr_b16 v[214:215], v254 offset:7168
  ds_read_b64_tr_b16 v[216:217], v255 offset:3072
  ds_read_b64_tr_b16 v[218:219], v255 offset:7168
  s_mov_b32 s8, 3000
fp_29:
  buffer_load_dword v13, v15, s[72:75], s83 offen sc1
  s_waitcnt vmcnt(0)
  v_cmp_ne_u32 vcc, s15, v13
  s_cbranch_vccz fpd_30
  s_sleep 8
  s_sub_u32 s8, s8, 1
  s_cmp_lg_u32 s8, 0
  s_cbranch_scc1 fp_29
fpd_30:
  buffer_load_dwordx4 v[40:43], v9, s[44:47], s82 offen sc1
  buffer_load_dwordx4 v[44:47], v10, s[44:47], s82 offen sc1
  s_add_u32 s82, s82, 2048
  buffer_load_dwordx4 v[48:51], v9, s[44:47], s82 offen sc1
  buffer_load_dwordx4 v[52:55], v10, s[44:47], s82 offen sc1
  s_add_u32 s82, s82, 2048
  buffer_load_dwordx4 v[56:59], v9, s[44:47], s82 offen sc1
  buffer_load_dwordx4 v[60:63], v10, s[44:47], s82 offen sc1
  s_add_u32 s82, s82, 2048
  buffer_load_dwordx4 v[64:67], v9, s[44:47], s82 offen sc1
  buffer_load_dwordx4 v[68:71], v10, s[44:47], s82 offen sc1
  s_add_u32 s82, s82, 2048
  ds_read_b64_tr_b16 v[16:17], v6 offset:0
  ds_read_b64_tr_b16 v[18:19], v6 offset:768
  ds_read_b64_tr_b16 v[20:21], v7 offset:0
  ds_read_b64_tr_b16 v[22:23], v7 offset:768
  ds_read_b64_tr_b16 v[24:25], v8 offset:0
  ds_read_b64_tr_b16 v[26:27], v8 offset:768
  s_sub_u32 s7, s10, s84
  s_waitcnt lgkmcnt(6)
  v_add_u32 v250, s7, v250
  v_add_u32 v251, s7, v251
  v_add_u32 v252, s7, v252
  v_add_u32 v253, s7, v253
  v_add_u32 v254, s7, v254
  v_add_u32 v255, s7, v255
  s_waitcnt lgkmcnt(0)
  v_mov_b32 v12, 162848
  v_mov_b32 v13, 1
  s_mov_b64 exec, 1
  ds_add_u32 v12, v13
  s_mov_b64 exec, -1
  s_cmp_eq_u32 s9, 3
  s_cselect_b32 s8, 6, 7
  s_waitcnt vmcnt(0)
  s_setprio 0
.p2align 6
f2_loop:
  s_waitcnt vmcnt(10) lgkmcnt(0)
  v_mfma_f32_32x32x16_bf16 v[80:95], v[16:19], v[40:43], v[80:95]
  ds_read_b64_tr_b16 v[28:29], v6 offset:4096
  ds_read_b64_tr_b16 v[30:31], v6 offset:4864
  ds_read_b64_tr_b16 v[32:33], v7 offset:4096
  v_mfma_f32_32x32x16_bf16 v[96:111], v[16:19], v[44:47], v[96:111]
  ds_read_b64_tr_b16 v[34:35], v7 offset:4864
  ds_read_b64_tr_b16 v[36:37], v8 offset:4096
  ds_read_b64_tr_b16 v[38:39], v8 offset:4864
  v_mfma_f32_32x32x16_bf16 v[112:127], v[20:23], v[40:43], v[112:127]
  s_add_u32 m0, s10, 0
  s_nop 0
  buffer_load_dwordx4 v2, s[64:67], s11 offen lds
  v_mfma_f32_32x32x16_bf16 v[128:143], v[20:23], v[44:47], v[128:143]
  s_add_u32 m0, s10, 1024
  s_nop 0
  buffer_load_dwordx4 v3, s[64:67], s11 offen lds
  v_mfma_f32_32x32x16_bf16 v[144:159], v[24:27], v[40:43], v[144:159]
  s_add_u32 m0, s10, 2048
  s_nop 0
  buffer_load_dwordx4 v4, s[64:67], s11 offen lds
  s_add_u32 s11, s11, 20480
  buffer_load_dwordx4 v[40:43], v9, s[44:47], s82 offen sc1
  buffer_load_dwordx4 v[44:47], v10, s[44:47], s82 offen sc1
  s_add_u32 s82, s82, 2048
  s_waitcnt vmcnt(10) lgkmcnt(0)
  v_mfma_f32_32x32x16_bf16 v[80:95], v[28:31], v[48:51], v[80:95]
  ds_read_b64_tr_b16 v[16:17], v6 offset:8192
  ds_read_b64_tr_b16 v[18:19], v6 offset:8960
  ds_read_b64_tr_b16 v[20:21], v7 offset:8192
  v_mfma_f32_32x32x16_bf16 v[96:111], v[28:31], v[52:55], v[96:111]
  ds_read_b64_tr_b16 v[22:23], v7 offset:8960
  ds_read_b64_tr_b16 v[24:25], v8 offset:8192
  ds_read_b64_tr_b16 v[26:27], v8 offset:8960
  v_mfma_f32_32x32x16_bf16 v[112:127], v[32:35], v[48:51], v[112:127]
  s_add_u32 m0, s10, 4096
  s_nop 0
  buffer_load_dwordx4 v2, s[64:67], s11 offen lds
  v_mfma_f32_32x32x16_bf16 v[128:143], v[32:35], v[52:55], v[128:143]
  s_add_u32 m0, s10, 5120
  s_nop 0
  buffer_load_dwordx4 v3, s[64:67], s11 offen lds
  v_mfma_f32_32x32x16_bf16 v[144:159], v[36:39], v[48:51], v[144:159]
  s_add_u32 m0, s10, 6144
  s_nop 0
  buffer_load_dwordx4 v4, s[64:67], s11 offen lds
  s_add_u32 s11, s11, 20480
  buffer_load_dwordx4 v[48:51], v9, s[44:47], s82 offen sc1
  buffer_load_dwordx4 v[52:55], v10, s[44:47], s82 offen sc1
  s_add_u32 s82, s82, 2048
  s_waitcnt vmcnt(10) lgkmcnt(0)
  v_mfma_f32_32x32x16_bf16 v[80:95], v[16:19], v[56:59], v[80:95]
  ds_read_b64_tr_b16 v[28:29], v6 offset:12288
  ds_read_b64_tr_b16 v[30:31], v6 offset:13056
  ds_read_b64_tr_b16 v[32:33], v7 offset:12288
  v_mfma_f32_32x32x16_bf16 v[96:111], v[16:19], v[60:63], v[96:111]
  ds_read_b64_tr_b16 v[34:35], v7 offset:13056
  ds_read_b64_tr_b16 v[36:37], v8 offset:12288
  ds_read_b64_tr_b16 v[38:39], v8 offset:13056
  v_mfma_f32_32x32x16_bf16 v[112:127], v[20:23], v[56:59], v[112:127]
  s_add_u32 m0, s10, 8192
  s_nop 0
  buffer_load_dwordx4 v2, s[64:67], s11 offen lds
  v_mfma_f32_32x32x16_bf16 v[128:143], v[20:23], v[60:63], v[128:143]
  s_add_u32 m0, s10, 9216
  s_nop 0
  buffer_load_dwordx4 v3, s[64:67], s11 offen lds
  v_mfma_f32_32x32x16_bf16 v[144:159], v[24:27], v[56:59], v[144:159]
  s_add_u32 m0, s10, 10240
  s_nop 0
  buffer_load_dwordx4 v4, s[64:67], s11 offen lds
  s_add_u32 s11, s11, 20480
  buffer_load_dwordx4 v[56:59], v9, s[44:47], s82 offen sc1
  buffer_load_dwordx4 v[60:63], v10, s[44:47], s82 offen sc1
  s_add_u32 s82, s82, 2048
  s_waitcnt vmcnt(10) lgkmcnt(0)
  v_mfma_f32_32x32x16_bf16 v[80:95], v[28:31], v[64:67], v[80:95]
  ds_read_b64_tr_b16 v[16:17], v6 offset:0
  ds_read_b64_tr_b16 v[18:19], v6 offset:768
  ds_read_b64_tr_b16 v[20:21], v7 offset:0
  v_mfma_f32_32x32x16_bf16 v[96:111], v[28:31], v[68:71], v[96:111]
  ds_read_b64_tr_b16 v[22:23], v7 offset:768
  ds_read_b64_tr_b16 v[24:25], v8 offset:0
  ds_read_b64_tr_b16 v[26:27], v8 offset:768
  v_mfma_f32_32x32x16_bf16 v[112:127], v[32:35], v[64:67], v[112:127]
  s_add_u32 m0, s10, 12288
  s_nop 0
  buffer_load_dwordx4 v2, s[64:67], s11 offen lds
  v_mfma_f32_32x32x16_bf16 v[128:143], v[32:35], v[68:71], v[128:143]
  s_add_u32 m0, s10, 13312
  s_nop 0
  buffer_load_dwordx4 v3, s[64:67], s11 offen lds
  v_mfma_f32_32x32x16_bf16 v[144:159], v[36:39], v[64:67], v[144:159]
  s_add_u32 m0, s10, 14336
  s_nop 0
  buffer_load_dwordx4 v4, s[64:67], s11 offen lds
  s_add_u32 s11, s11, 20480
  buffer_load_dwordx4 v[64:67], v9, s[44:47], s82 offen sc1
  buffer_load_dwordx4 v[68:71], v10, s[44:47], s82 offen sc1
  s_add_u32 s82, s82, 2048
  s_sub_u32 s8, s8, 1
  s_cmp_lg_u32 s8, 0
  s_cbranch_scc1 f2_loop
  s_setprio 2
  s_waitcnt vmcnt(0) lgkmcnt(0)
  v_and_b32 v1, 31, v0
  v_mul_u32_u24 v1, 1280, v1
  v_lshrrev_b32 v12, 5, v0
  v_lshl_add_u32 v1, v12, 3, v1
  s_lshl_b32 s7, s9, 4
  s_add_u32 s7, s7, s77
  s_mul_i32 s8, s4, 81920
  s_add_u32 s7, s7, s8
  s_mul_i32 s8, s76, 40960
  s_sub_u32 s11, 40960, s8
  s_add_u32 s8, s8, s7
  s_add_u32 s11, s11, s7
  s_add_u32 s83, s79, s8
  s_add_u32 s85, s79, s11
  s_add_u32 s6, s80, s8
  s_add_u32 s12, s80, s11
  s_add_u32 s13, s81, s8
  v_lshlrev_b32 v12, 4, v0
  s_sub_u32 s7, s9, 1
  s_and_b32 s7, s7, 3
  s_lshl_b32 s7, s7, 14
  s_add_u32 s7, s7, 81920
  v_add_u32 v13, s7, v12
  s_sub_u32 s7, s9, 2
  s_and_b32 s7, s7, 3
  s_lshl_b32 s7, s7, 14
  s_add_u32 s7, s7, 81920
  v_add_u32 v14, s7, v12
  s_sub_u32 s7, s9, 3
  s_and_b32 s7, s7, 3
  s_lshl_b32 s7, s7, 14
  s_add_u32 s7, s7, 81920
  v_add_u32 v15, s7, v12
  v_add_u32 v12, s10, v12
  ds_write_b128 v12, v[84:87] offset:0
  ds_write_b128 v12, v[88:91] offset:1024
  ds_write_b128 v12, v[92:95] offset:2048
  ds_write_b128 v12, v[100:103] offset:3072
  ds_write_b128 v12, v[104:107] offset:4096
  ds_write_b128 v12, v[108:111] offset:5120
  ds_write_b128 v12, v[116:119] offset:6144
  ds_write_b128 v12, v[120:123] offset:7168
  ds_write_b128 v12, v[124:127] offset:8192
  ds_write_b128 v12, v[132:135] offset:9216
  ds_write_b128 v12, v[136:139] offset:10240
  ds_write_b128 v12, v[140:143] offset:11264
  ds_write_b128 v12, v[148:151] offset:12288
  ds_write_b128 v12, v[152:155] offset:13312
  ds_write_b128 v12, v[156:159] offset:14336
  s_waitcnt lgkmcnt(0)
  v_mov_b32 v16, 162824
  v_mov_b32 v17, 1
  s_mov_b64 exec, 1
  ds_add_u32 v16, v17
  s_mov_b64 exec, -1
  v_mov_b32 v16, 162824
  s_mov_b32 s8, 0x40000
lw_31:
  ds_read_b32 v17, v16
  s_waitcnt lgkmcnt(0)
  v_readfirstlane_b32 s7, v17
  s_cmp_ge_u32 s7, 4
  s_cbranch_scc1 lwd_32
  s_sub_u32 s8, s8, 1
  s_cmp_lg_u32 s8, 0
  s_cbranch_scc1 lw_31
lwd_32:
  ds_read_b128 v[16:19], v13 offset:0
  ds_read_b128 v[20:23], v14 offset:1024
  ds_read_b128 v[24:27], v15 offset:2048
  ds_read_b128 v[28:31], v13 offset:3072
  ds_read_b128 v[32:35], v14 offset:4096
  ds_read_b128 v[36:39], v15 offset:5120
  ds_read_b128 v[40:43], v13 offset:6144
  ds_read_b128 v[44:47], v14 offset:7168
  ds_read_b128 v[48:51], v15 offset:8192
  ds_read_b128 v[52:55], v13 offset:9216
  ds_read_b128 v[56:59], v14 offset:10240
  ds_read_b128 v[60:63], v15 offset:11264
  ds_read_b128 v[64:67], v13 offset:12288
  ds_read_b128 v[68:71], v14 offset:13312
  ds_read_b128 v[72:75], v15 offset:14336
  s_waitcnt lgkmcnt(0)
  v_mov_b32 v76, 162824
  v_mov_b32 v77, 1
  s_mov_b64 exec, 1
  ds_add_u32 v76, v77
  s_mov_b64 exec, -1
  v_mov_b32 v76, 162824
  s_mov_b32 s8, 0x40000
lw_33:
  ds_read_b32 v77, v76
  s_waitcnt lgkmcnt(0)
  v_readfirstlane_b32 s7, v77
  s_cmp_ge_u32 s7, 8
  s_cbranch_scc1 lwd_34
  s_sub_u32 s8, s8, 1
  s_cmp_lg_u32 s8, 0
  s_cbranch_scc1 lw_33
lwd_34:
  s_mul_i32 s7, s9, 102400
  s_add_u32 s7, s7, 409600
  s_add_u32 m0, s10, 0
  s_nop 0
  buffer_load_dwordx4 v2, s[52:55], s7 offen lds
  s_add_u32 m0, s10, 1024
  s_nop 0
  buffer_load_dwordx4 v3, s[52:55], s7 offen lds
  s_add_u32 m0, s10, 2048
  s_nop 0
  buffer_load_dwordx4 v4, s[52:55], s7 offen lds
  s_add_u32 m0, s10, 3072
  s_nop 0
  buffer_load_dwordx4 v5, s[52:55], s7 offen lds
  s_mul_i32 s7, s9, 102400
  s_add_u32 s7, s7, 435200
  s_add_u32 m0, s10, 4096
  s_nop 0
  buffer_load_dwordx4 v2, s[52:55], s7 offen lds
  s_add_u32 m0, s10, 5120
  s_nop 0
  buffer_load_dwordx4 v3, s[52:55], s7 offen lds
  s_add_u32 m0, s10, 6144
  s_nop 0
  buffer_load_dwordx4 v4, s[52:55], s7 offen lds
  s_add_u32 m0, s10, 7168
  s_nop 0
  buffer_load_dwordx4 v5, s[52:55], s7 offen lds
  s_mul_i32 s7, s9, 102400
  s_add_u32 s7, s7, 460800
  s_add_u32 m0, s10, 8192
  s_nop 0
  buffer_load_dwordx4 v2, s[52:55], s7 offen lds
  s_add_u32 m0, s10, 9216
  s_nop 0
  buffer_load_dwordx4 v3, s[52:55], s7 offen lds
  s_add_u32 m0, s10, 10240
  s_nop 0
  buffer_load_dwordx4 v4, s[52:55], s7 offen lds
  s_add_u32 m0, s10, 11264
  s_nop 0
  buffer_load_dwordx4 v5, s[52:55], s7 offen lds
  s_mul_i32 s7, s9, 102400
  s_add_u32 s7, s7, 486400
  s_add_u32 m0, s10, 12288
  s_nop 0
  buffer_load_dwordx4 v2, s[52:55], s7 offen lds
  s_add_u32 m0, s10, 13312
  s_nop 0
  buffer_load_dwordx4 v3, s[52:55], s7 offen lds
  s_add_u32 m0, s10, 14336
  s_nop 0
  buffer_load_dwordx4 v4, s[52:55], s7 offen lds
  s_add_u32 m0, s10, 15360
  s_nop 0
  buffer_load_dwordx4 v5, s[52:55], s7 offen lds
  buffer_load_dwordx2 v[236:237], v1, s[40:43], s83 offen
  buffer_load_dwordx2 v[238:239], v1, s[40:43], s85 offen
  buffer_load_dwordx2 v[2:3], v1, s[40:43], s6 offen
  buffer_load_dwordx2 v[4:5], v1, s[40:43], s12 offen
  buffer_load_dwordx2 v[6:7], v1, s[40:43], s13 offen
  v_pk_add_f32 v[16:17], v[16:17], v[20:21]
  v_pk_add_f32 v[24:25], v[24:25], v[80:81]
  v_pk_add_f32 v[18:19], v[18:19], v[22:23]
  v_pk_add_f32 v[26:27], v[26:27], v[82:83]
  v_pk_add_f32 v[16:17], v[16:17], v[24:25]
  v_pk_add_f32 v[18:19], v[18:19], v[26:27]
  v_mul_f32 v20, 0xbfb8aa3b, v16
  v_mul_f32 v21, 0xbfb8aa3b, v17
  v_mul_f32 v22, 0xbfb8aa3b, v18
  v_mul_f32 v23, 0xbfb8aa3b, v19
  v_exp_f32 v20, v20
  v_exp_f32 v21, v21
  v_exp_f32 v22, v22
  v_exp_f32 v23, v23
  v_add_f32 v20, 1.0, v20
  v_add_f32 v21, 1.0, v21
  v_add_f32 v22, 1.0, v22
  v_add_f32 v23, 1.0, v23
  v_rcp_f32 v20, v20
  v_rcp_f32 v21, v21
  v_rcp_f32 v22, v22
  v_rcp_f32 v23, v23
  s_nop 0
  v_mul_f32 v16, v16, v20
  v_mul_f32 v17, v17, v21
  v_mul_f32 v18, v18, v22
  v_mul_f32 v19, v19, v23
  v_cvt_pk_bf16_f32 v240, v16, v17
  v_cvt_pk_bf16_f32 v241, v18, v19
  v_pk_add_f32 v[28:29], v[28:29], v[32:33]
  v_pk_add_f32 v[36:37], v[36:37], v[96:97]
  v_pk_add_f32 v[30:31], v[30:31], v[34:35]
  v_pk_add_f32 v[38:39], v[38:39], v[98:99]
  v_pk_add_f32 v[28:29], v[28:29], v[36:37]
  v_pk_add_f32 v[30:31], v[30:31], v[38:39]
  v_mul_f32 v32, 0xbfb8aa3b, v28
  v_mul_f32 v33, 0xbfb8aa3b, v29
  v_mul_f32 v34, 0xbfb8aa3b, v30
  v_mul_f32 v35, 0xbfb8aa3b, v31
  v_exp_f32 v32, v32
  v_exp_f32 v33, v33
  v_exp_f32 v34, v34
  v_exp_f32 v35, v35
  v_add_f32 v32, 1.0, v32
  v_add_f32 v33, 1.0, v33
  v_add_f32 v34, 1.0, v34
  v_add_f32 v35, 1.0, v35
  v_rcp_f32 v32, v32
  v_rcp_f32 v33, v33
  v_rcp_f32 v34, v34
  v_rcp_f32 v35, v35
  s_nop 0
  v_mul_f32 v28, v28, v32
  v_mul_f32 v29, v29, v33
  v_mul_f32 v30, v30, v34
  v_mul_f32 v31, v31, v35
  v_cvt_pk_bf16_f32 v242, v28, v29
  v_cvt_pk_bf16_f32 v243, v30, v31
  v_pk_add_f32 v[40:41], v[40:41], v[44:45]
  v_pk_add_f32 v[48:49], v[48:49], v[112:113]
  v_pk_add_f32 v[42:43], v[42:43], v[46:47]
  v_pk_add_f32 v[50:51], v[50:51], v[114:115]
  v_pk_add_f32 v[40:41], v[40:41], v[48:49]
  v_pk_add_f32 v[42:43], v[42:43], v[50:51]
  v_mul_f32 v44, 0xbfb8aa3b, v40
  v_mul_f32 v45, 0xbfb8aa3b, v41
  v_mul_f32 v46, 0xbfb8aa3b, v42
  v_mul_f32 v47, 0xbfb8aa3b, v43
  v_exp_f32 v44, v44
  v_exp_f32 v45, v45
  v_exp_f32 v46, v46
  v_exp_f32 v47, v47
  v_add_f32 v44, 1.0, v44
  v_add_f32 v45, 1.0, v45
  v_add_f32 v46, 1.0, v46
  v_add_f32 v47, 1.0, v47
  v_rcp_f32 v44, v44
  v_rcp_f32 v45, v45
  v_rcp_f32 v46, v46
  v_rcp_f32 v47, v47
  s_nop 0
  v_mul_f32 v40, v40, v44
  v_mul_f32 v41, v41, v45
  v_mul_f32 v42, v42, v46
  v_mul_f32 v43, v43, v47
  v_cvt_pk_bf16_f32 v244, v40, v41
  v_cvt_pk_bf16_f32 v245, v42, v43
  v_pk_add_f32 v[52:53], v[52:53], v[56:57]
  v_pk_add_f32 v[60:61], v[60:61], v[128:129]
  v_pk_add_f32 v[54:55], v[54:55], v[58:59]
  v_pk_add_f32 v[62:63], v[62:63], v[130:131]
  v_pk_add_f32 v[52:53], v[52:53], v[60:61]
  v_pk_add_f32 v[54:55], v[54:55], v[62:63]
  v_mul_f32 v56, 0xbfb8aa3b, v52
  v_mul_f32 v57, 0xbfb8aa3b, v53
  v_mul_f32 v58, 0xbfb8aa3b, v54
  v_mul_f32 v59, 0xbfb8aa3b, v55
  v_exp_f32 v56, v56
  v_exp_f32 v57, v57
  v_exp_f32 v58, v58
  v_exp_f32 v59, v59
  v_add_f32 v56, 1.0, v56
  v_add_f32 v57, 1.0, v57
  v_add_f32 v58, 1.0, v58
  v_add_f32 v59, 1.0, v59
  v_rcp_f32 v56, v56
  v_rcp_f32 v57, v57
  v_rcp_f32 v58, v58
  v_rcp_f32 v59, v59
  s_nop 0
  v_mul_f32 v52, v52, v56
  v_mul_f32 v53, v53, v57
  v_mul_f32 v54, v54, v58
  v_mul_f32 v55, v55, v59
  v_cvt_pk_bf16_f32 v246, v52, v53
  v_cvt_pk_bf16_f32 v247, v54, v55
  v_pk_add_f32 v[64:65], v[64:65], v[68:69]
  v_pk_add_f32 v[72:73], v[72:73], v[144:145]
  v_pk_add_f32 v[66:67], v[66:67], v[70:71]
  v_pk_add_f32 v[74:75], v[74:75], v[146:147]
  v_pk_add_f32 v[64:65], v[64:65], v[72:73]
  v_pk_add_f32 v[66:67], v[66:67], v[74:75]
  v_mul_f32 v68, 0xbfb8aa3b, v64
  v_mul_f32 v69, 0xbfb8aa3b, v65
  v_mul_f32 v70, 0xbfb8aa3b, v66
  v_mul_f32 v71, 0xbfb8aa3b, v67
  v_exp_f32 v68, v68
  v_exp_f32 v69, v69
  v_exp_f32 v70, v70
  v_exp_f32 v71, v71
  v_add_f32 v68, 1.0, v68
  v_add_f32 v69, 1.0, v69
  v_add_f32 v70, 1.0, v70
  v_add_f32 v71, 1.0, v71
  v_rcp_f32 v68, v68
  v_rcp_f32 v69, v69
  v_rcp_f32 v70, v70
  v_rcp_f32 v71, v71
  s_nop 0
  v_mul_f32 v64, v64, v68
  v_mul_f32 v65, v65, v69
  v_mul_f32 v66, v66, v70
  v_mul_f32 v67, v67, v71
  v_cvt_pk_bf16_f32 v248, v64, v65
  v_cvt_pk_bf16_f32 v249, v66, v67
  v_min_u32 v12, 7, v0
  v_lshlrev_b32 v12, 7, v12
  s_lshl_b32 s7, s4, 3
  s_add_u32 s7, s7, s5
  s_lshl_b32 s7, s7, 2
  s_add_u32 s7, s7, s9
  s_lshl_b32 s7, s7, 10
  s_add_u32 s7, s7, 16777216
  s_mul_i32 s82, s4, 81920
  s_mul_i32 s8, s9, 10240
  s_add_u32 s82, s82, s8
  s_add_u32 s82, s82, 8388608
  v_and_b32 v14, 31, v0
  v_lshlrev_b32 v14, 4, v14
  v_lshrrev_b32 v15, 5, v0
  v_lshl_add_u32 v14, v15, 10, v14
  s_lshl_b32 s8, s76, 9
  v_add_u32 v14, s8, v14
  v_xor_b32 v15, 0x200, v14
  s_setprio 3
  s_mov_b32 s8, 3000
o_poll0:
  buffer_load_dword v13, v12, s[72:75], s7 offen sc1
  s_waitcnt vmcnt(0)
  v_cmp_ne_u32 vcc, s15, v13
  s_and_b32 s11, vcc_lo, 15
  s_cbranch_scc0 o_go0
  s_sleep 16
  s_sub_u32 s8, s8, 1
  s_cmp_lg_u32 s8, 0
  s_cbranch_scc1 o_poll0
o_go0:
  s_setprio 3
  buffer_load_dwordx4 v[16:19], v9, s[72:75], s82 offen sc1
  buffer_load_dwordx4 v[20:23], v10, s[72:75], s82 offen sc1
  s_add_u32 s82, s82, 2048
  buffer_load_dwordx4 v[24:27], v9, s[72:75], s82 offen sc1
  buffer_load_dwordx4 v[28:31], v10, s[72:75], s82 offen sc1
  s_add_u32 s82, s82, 2048
  buffer_load_dwordx4 v[32:35], v9, s[72:75], s82 offen sc1
  buffer_load_dwordx4 v[36:39], v10, s[72:75], s82 offen sc1
  s_add_u32 s82, s82, 2048
  buffer_load_dwordx4 v[40:43], v9, s[72:75], s82 offen sc1
  buffer_load_dwordx4 v[44:47], v10, s[72:75], s82 offen sc1
  s_add_u32 s82, s82, 2048
  buffer_load_dwordx4 v[48:51], v14, s[72:75], s82 offen sc1
  buffer_load_dwordx4 v[52:55], v15, s[72:75], s82 offen sc1
  s_add_u32 s82, s82, 2048
  s_add_u32 s82, s82, 30720
  s_cbranch_vccnz o_slow
  buffer_load_dwordx4 v[56:59], v9, s[72:75], s82 offen sc1
  buffer_load_dwordx4 v[60:63], v10, s[72:75], s82 offen sc1
  s_add_u32 s82, s82, 2048
  buffer_load_dwordx4 v[64:67], v9, s[72:75], s82 offen sc1
  buffer_load_dwordx4 v[68:71], v10, s[72:75], s82 offen sc1
  s_add_u32 s82, s82, 2048
  buffer_load_dwordx4 v[72:75], v9, s[72:75], s82 offen sc1
  buffer_load_dwordx4 v[76:79], v10, s[72:75], s82 offen sc1
  s_add_u32 s82, s82, 2048
  buffer_load_dwordx4 v[220:223], v9, s[72:75], s82 offen sc1
  buffer_load_dwordx4 v[224:227], v10, s[72:75], s82 offen sc1
  s_add_u32 s82, s82, 2048
  buffer_load_dwordx4 v[228:231], v14, s[72:75], s82 offen sc1
  buffer_load_dwordx4 v[232:235], v15, s[72:75], s82 offen sc1
  s_add_u32 s82, s82, 2048
  s_add_u32 s82, s82, 30720
  s_waitcnt vmcnt(18)
  v_mfma_f32_32x32x16_bf16 v[80:95], v[160:163], v[16:19], 0
  v_mfma_f32_32x32x16_bf16 v[96:111], v[160:163], v[20:23], 0
  v_mfma_f32_32x32x16_bf16 v[112:127], v[164:167], v[16:19], 0
  v_mfma_f32_32x32x16_bf16 v[128:143], v[164:167], v[20:23], 0
  v_mfma_f32_32x32x16_bf16 v[144:159], v[168:171], v[16:19], 0
  ds_read_b64_tr_b16 v[160:161], v250 offset:0
  ds_read_b64_tr_b16 v[162:163], v250 offset:1536
  ds_read_b64_tr_b16 v[164:165], v251 offset:0
  ds_read_b64_tr_b16 v[166:167], v251 offset:1536
  ds_read_b64_tr_b16 v[168:169], v252 offset:0
  ds_read_b64_tr_b16 v[170:171], v252 offset:1536
  s_waitcnt vmcnt(16)
  v_mfma_f32_32x32x16_bf16 v[80:95], v[172:175], v[24:27], v[80:95]
  v_mfma_f32_32x32x16_bf16 v[96:111], v[172:175], v[28:31], v[96:111]
  v_mfma_f32_32x32x16_bf16 v[112:127], v[176:179], v[24:27], v[112:127]
  v_mfma_f32_32x32x16_bf16 v[128:143], v[176:179], v[28:31], v[128:143]
  v_mfma_f32_32x32x16_bf16 v[144:159], v[180:183], v[24:27], v[144:159]
  ds_read_b64_tr_b16 v[172:173], v250 offset:4096
  ds_read_b64_tr_b16 v[174:175], v250 offset:5632
  ds_read_b64_tr_b16 v[176:177], v251 offset:4096
  ds_read_b64_tr_b16 v[178:179], v251 offset:5632
  ds_read_b64_tr_b16 v[180:181], v252 offset:4096
  ds_read_b64_tr_b16 v[182:183], v252 offset:5632
  s_waitcnt vmcnt(14)
  v_mfma_f32_32x32x16_bf16 v[80:95], v[184:187], v[32:35], v[80:95]
  v_mfma_f32_32x32x16_bf16 v[96:111], v[184:187], v[36:39], v[96:111]
  v_mfma_f32_32x32x16_bf16 v[112:127], v[188:191], v[32:35], v[112:127]
  v_mfma_f32_32x32x16_bf16 v[128:143], v[188:191], v[36:39], v[128:143]
  v_mfma_f32_32x32x16_bf16 v[144:159], v[192:195], v[32:35], v[144:159]
  ds_read_b64_tr_b16 v[184:185], v250 offset:8192
  ds_read_b64_tr_b16 v[186:187], v250 offset:9728
  ds_read_b64_tr_b16 v[188:189], v251 offset:8192
  ds_read_b64_tr_b16 v[190:191], v251 offset:9728
  ds_read_b64_tr_b16 v[192:193], v252 offset:8192
  ds_read_b64_tr_b16 v[194:195], v252 offset:9728
  s_waitcnt vmcnt(12)
  v_mfma_f32_32x32x16_bf16 v[80:95], v[196:199], v[40:43], v[80:95]
  v_mfma_f32_32x32x16_bf16 v[96:111], v[196:199], v[44:47], v[96:111]
  v_mfma_f32_32x32x16_bf16 v[112:127], v[200:203], v[40:43], v[112:127]
  v_mfma_f32_32x32x16_bf16 v[128:143], v[200:203], v[44:47], v[128:143]
  v_mfma_f32_32x32x16_bf16 v[144:159], v[204:207], v[40:43], v[144:159]
  ds_read_b64_tr_b16 v[196:197], v250 offset:12288
  ds_read_b64_tr_b16 v[198:199], v250 offset:13824
  ds_read_b64_tr_b16 v[200:201], v251 offset:12288
  ds_read_b64_tr_b16 v[202:203], v251 offset:13824
  ds_read_b64_tr_b16 v[204:205], v252 offset:12288
  ds_read_b64_tr_b16 v[206:207], v252 offset:13824
  s_waitcnt vmcnt(10)
  s_cmp_lg_u32 s76, 0
  s_cbranch_scc1 f5o_35
  v_swap_b32 v50, v52
  v_swap_b32 v51, v53
  s_branch f5d_36
f5o_35:
  v_swap_b32 v48, v54
  v_swap_b32 v49, v55
f5d_36:
  s_nop 1
  v_mfma_f32_32x32x16_bf16 v[80:95], v[208:211], v[48:51], v[80:95]
  v_mfma_f32_32x32x16_bf16 v[96:111], v[208:211], v[52:55], v[96:111]
  v_mfma_f32_32x32x16_bf16 v[112:127], v[212:215], v[48:51], v[112:127]
  v_mfma_f32_32x32x16_bf16 v[128:143], v[212:215], v[52:55], v[128:143]
  v_mfma_f32_32x32x16_bf16 v[144:159], v[216:219], v[48:51], v[144:159]
  ds_read_b64_tr_b16 v[208:209], v253 offset:3072
  ds_read_b64_tr_b16 v[210:211], v253 offset:7168
  ds_read_b64_tr_b16 v[212:213], v254 offset:3072
  ds_read_b64_tr_b16 v[214:215], v254 offset:7168
  ds_read_b64_tr_b16 v[216:217], v255 offset:3072
  ds_read_b64_tr_b16 v[218:219], v255 offset:7168
  s_branch o_second
o_slow:
  buffer_load_dword v13, v12, s[72:75], s7 offen sc1
  s_waitcnt vmcnt(9)
  v_mfma_f32_32x32x16_bf16 v[80:95], v[160:163], v[16:19], 0
  v_mfma_f32_32x32x16_bf16 v[96:111], v[160:163], v[20:23], 0
  v_mfma_f32_32x32x16_bf16 v[112:127], v[164:167], v[16:19], 0
  v_mfma_f32_32x32x16_bf16 v[128:143], v[164:167], v[20:23], 0
  v_mfma_f32_32x32x16_bf16 v[144:159], v[168:171], v[16:19], 0
  ds_read_b64_tr_b16 v[160:161], v250 offset:0
  ds_read_b64_tr_b16 v[162:163], v250 offset:1536
  ds_read_b64_tr_b16 v[164:165], v251 offset:0
  ds_read_b64_tr_b16 v[166:167], v251 offset:1536
  ds_read_b64_tr_b16 v[168:169], v252 offset:0
  ds_read_b64_tr_b16 v[170:171], v252 offset:1536
  s_waitcnt vmcnt(7)
  v_mfma_f32_32x32x16_bf16 v[80:95], v[172:175], v[24:27], v[80:95]
  v_mfma_f32_32x32x16_bf16 v[96:111], v[172:175], v[28:31], v[96:111]
  v_mfma_f32_32x32x16_bf16 v[112:127], v[176:179], v[24:27], v[112:127]
  v_mfma_f32_32x32x16_bf16 v[128:143], v[176:179], v[28:31], v[128:143]
  v_mfma_f32_32x32x16_bf16 v[144:159], v[180:183], v[24:27], v[144:159]
  ds_read_b64_tr_b16 v[172:173], v250 offset:4096
  ds_read_b64_tr_b16 v[174:175], v250 offset:5632
  ds_read_b64_tr_b16 v[176:177], v251 offset:4096
  ds_read_b64_tr_b16 v[178:179], v251 offset:5632
  ds_read_b64_tr_b16 v[180:181], v252 offset:4096
  ds_read_b64_tr_b16 v[182:183], v252 offset:5632
  s_waitcnt vmcnt(5)
  v_mfma_f32_32x32x16_bf16 v[80:95], v[184:187], v[32:35], v[80:95]
  v_mfma_f32_32x32x16_bf16 v[96:111], v[184:187], v[36:39], v[96:111]
  v_mfma_f32_32x32x16_bf16 v[112:127], v[188:191], v[32:35], v[112:127]
  v_mfma_f32_32x32x16_bf16 v[128:143], v[188:191], v[36:39], v[128:143]
  v_mfma_f32_32x32x16_bf16 v[144:159], v[192:195], v[32:35], v[144:159]
  ds_read_b64_tr_b16 v[184:185], v250 offset:8192
  ds_read_b64_tr_b16 v[186:187], v250 offset:9728
  ds_read_b64_tr_b16 v[188:189], v251 offset:8192
  ds_read_b64_tr_b16 v[190:191], v251 offset:9728
  ds_read_b64_tr_b16 v[192:193], v252 offset:8192
  ds_read_b64_tr_b16 v[194:195], v252 offset:9728
  s_waitcnt vmcnt(3)
  v_mfma_f32_32x32x16_bf16 v[80:95], v[196:199], v[40:43], v[80:95]
  v_mfma_f32_32x32x16_bf16 v[96:111], v[196:199], v[44:47], v[96:111]
  v_mfma_f32_32x32x16_bf16 v[112:127], v[200:203], v[40:43], v[112:127]
  v_mfma_f32_32x32x16_bf16 v[128:143], v[200:203], v[44:47], v[128:143]
  v_mfma_f32_32x32x16_bf16 v[144:159], v[204:207], v[40:43], v[144:159]
  ds_read_b64_tr_b16 v[196:197], v250 offset:12288
  ds_read_b64_tr_b16 v[198:199], v250 offset:13824
  ds_read_b64_tr_b16 v[200:201], v251 offset:12288
  ds_read_b64_tr_b16 v[202:203], v251 offset:13824
  ds_read_b64_tr_b16 v[204:205], v252 offset:12288
  ds_read_b64_tr_b16 v[206:207], v252 offset:13824
  s_waitcnt vmcnt(1)
  s_cmp_lg_u32 s76, 0
  s_cbranch_scc1 f5o_37
  v_swap_b32 v50, v52
  v_swap_b32 v51, v53
  s_branch f5d_38
f5o_37:
  v_swap_b32 v48, v54
  v_swap_b32 v49, v55
f5d_38:
  s_nop 1
  v_mfma_f32_32x32x16_bf16 v[80:95], v[208:211], v[48:51], v[80:95]
  v_mfma_f32_32x32x16_bf16 v[96:111], v[208:211], v[52:55], v[96:111]
  v_mfma_f32_32x32x16_bf16 v[112:127], v[212:215], v[48:51], v[112:127]
  v_mfma_f32_32x32x16_bf16 v[128:143], v[212:215], v[52:55], v[128:143]
  v_mfma_f32_32x32x16_bf16 v[144:159], v[216:219], v[48:51], v[144:159]
  ds_read_b64_tr_b16 v[208:209], v253 offset:3072
  ds_read_b64_tr_b16 v[210:211], v253 offset:7168
  ds_read_b64_tr_b16 v[212:213], v254 offset:3072
  ds_read_b64_tr_b16 v[214:215], v254 offset:7168
  ds_read_b64_tr_b16 v[216:217], v255 offset:3072
  ds_read_b64_tr_b16 v[218:219], v255 offset:7168
  s_waitcnt vmcnt(0)
  v_cmp_ne_u32 vcc, s15, v13
  s_cbranch_vccz o_go1
  s_mov_b32 s8, 3000
fp_39:
  buffer_load_dword v13, v12, s[72:75], s7 offen sc1
  s_waitcnt vmcnt(0)
  v_cmp_ne_u32 vcc, s15, v13
  s_cbranch_vccz fpd_40
  s_sleep 8
  s_sub_u32 s8, s8, 1
  s_cmp_lg_u32 s8, 0
  s_cbranch_scc1 fp_39
fpd_40:
o_go1:
  buffer_load_dwordx4 v[56:59], v9, s[72:75], s82 offen sc1
  buffer_load_dwordx4 v[60:63], v10, s[72:75], s82 offen sc1
  s_add_u32 s82, s82, 2048
  buffer_load_dwordx4 v[64:67], v9, s[72:75], s82 offen sc1
  buffer_load_dwordx4 v[68:71], v10, s[72:75], s82 offen sc1
  s_add_u32 s82, s82, 2048
  buffer_load_dwordx4 v[72:75], v9, s[72:75], s82 offen sc1
  buffer_load_dwordx4 v[76:79], v10, s[72:75], s82 offen sc1
  s_add_u32 s82, s82, 2048
  buffer_load_dwordx4 v[220:223], v9, s[72:75], s82 offen sc1
  buffer_load_dwordx4 v[224:227], v10, s[72:75], s82 offen sc1
  s_add_u32 s82, s82, 2048
  buffer_load_dwordx4 v[228:231], v14, s[72:75], s82 offen sc1
  buffer_load_dwordx4 v[232:235], v15, s[72:75], s82 offen sc1
  s_add_u32 s82, s82, 2048
  s_add_u32 s82, s82, 30720
o_second:
  s_waitcnt vmcnt(8) lgkmcnt(15)
  v_mfma_f32_32x32x16_bf16 v[80:95], v[160:163], v[56:59], v[80:95]
  v_mfma_f32_32x32x16_bf16 v[96:111], v[160:163], v[60:63], v[96:111]
  v_mfma_f32_32x32x16_bf16 v[112:127], v[164:167], v[56:59], v[112:127]
  v_mfma_f32_32x32x16_bf16 v[128:143], v[164:167], v[60:63], v[128:143]
  v_mfma_f32_32x32x16_bf16 v[144:159], v[168:171], v[56:59], v[144:159]
  s_waitcnt vmcnt(6) lgkmcnt(15)
  v_mfma_f32_32x32x16_bf16 v[80:95], v[172:175], v[64:67], v[80:95]
  v_mfma_f32_32x32x16_bf16 v[96:111], v[172:175], v[68:71], v[96:111]
  v_mfma_f32_32x32x16_bf16 v[112:127], v[176:179], v[64:67], v[112:127]
  v_mfma_f32_32x32x16_bf16 v[128:143], v[176:179], v[68:71], v[128:143]
  v_mfma_f32_32x32x16_bf16 v[144:159], v[180:183], v[64:67], v[144:159]
  s_waitcnt vmcnt(4) lgkmcnt(12)
  v_mfma_f32_32x32x16_bf16 v[80:95], v[184:187], v[72:75], v[80:95]
  v_mfma_f32_32x32x16_bf16 v[96:111], v[184:187], v[76:79], v[96:111]
  v_mfma_f32_32x32x16_bf16 v[112:127], v[188:191], v[72:75], v[112:127]
  v_mfma_f32_32x32x16_bf16 v[128:143], v[188:191], v[76:79], v[128:143]
  v_mfma_f32_32x32x16_bf16 v[144:159], v[192:195], v[72:75], v[144:159]
  s_waitcnt vmcnt(2) lgkmcnt(6)
  v_mfma_f32_32x32x16_bf16 v[80:95], v[196:199], v[220:223], v[80:95]
  v_mfma_f32_32x32x16_bf16 v[96:111], v[196:199], v[224:227], v[96:111]
  v_mfma_f32_32x32x16_bf16 v[112:127], v[200:203], v[220:223], v[112:127]
  v_mfma_f32_32x32x16_bf16 v[128:143], v[200:203], v[224:227], v[128:143]
  v_mfma_f32_32x32x16_bf16 v[144:159], v[204:207], v[220:223], v[144:159]
  s_waitcnt vmcnt(0) lgkmcnt(0)
  s_cmp_lg_u32 s76, 0
  s_cbranch_scc1 f5o_41
  v_swap_b32 v230, v232
  v_swap_b32 v231, v233
  s_branch f5d_42
f5o_41:
  v_swap_b32 v228, v234
  v_swap_b32 v229, v235
f5d_42:
  s_nop 1
  v_mfma_f32_32x32x16_bf16 v[80:95], v[208:211], v[228:231], v[80:95]
  v_mfma_f32_32x32x16_bf16 v[96:111], v[208:211], v[232:235], v[96:111]
  v_mfma_f32_32x32x16_bf16 v[112:127], v[212:215], v[228:231], v[112:127]
  v_mfma_f32_32x32x16_bf16 v[128:143], v[212:215], v[232:235], v[128:143]
  v_mfma_f32_32x32x16_bf16 v[144:159], v[216:219], v[228:231], v[144:159]
  v_lshlrev_b32 v12, 4, v0
  s_sub_u32 s7, s9, 1
  s_and_b32 s7, s7, 3
  s_lshl_b32 s7, s7, 14
  s_add_u32 s7, s7, 81920
  v_add_u32 v13, s7, v12
  s_sub_u32 s7, s9, 2
  s_and_b32 s7, s7, 3
  s_lshl_b32 s7, s7, 14
  s_add_u32 s7, s7, 81920
  v_add_u32 v14, s7, v12
  s_sub_u32 s7, s9, 3
  s_and_b32 s7, s7, 3
  s_lshl_b32 s7, s7, 14
  s_add_u32 s7, s7, 81920
  v_add_u32 v15, s7, v12
  v_add_u32 v12, s10, v12
  ds_write_b128 v12, v[84:87] offset:0
  ds_write_b128 v12, v[88:91] offset:1024
  ds_write_b128 v12, v[92:95] offset:2048
  ds_write_b128 v12, v[100:103] offset:3072
  ds_write_b128 v12, v[104:107] offset:4096
  ds_write_b128 v12, v[108:111] offset:5120
  ds_write_b128 v12, v[116:119] offset:6144
  ds_write_b128 v12, v[120:123] offset:7168
  ds_write_b128 v12, v[124:127] offset:8192
  ds_write_b128 v12, v[132:135] offset:9216
  ds_write_b128 v12, v[136:139] offset:10240
  ds_write_b128 v12, v[140:143] offset:11264
  ds_write_b128 v12, v[148:151] offset:12288
  ds_write_b128 v12, v[152:155] offset:13312
  ds_write_b128 v12, v[156:159] offset:14336
  s_waitcnt lgkmcnt(0)
  v_mov_b32 v230, 162828
  v_mov_b32 v231, 1
  s_mov_b64 exec, 1
  ds_add_u32 v230, v231
  s_mov_b64 exec, -1
  s_mov_b32 s78, 0xffff0000
  v_lshlrev_b32 v16, 16, v236
  v_and_b32 v17, s78, v236
  v_lshlrev_b32 v18, 16, v237
  v_and_b32 v19, s78, v237
  v_lshlrev_b32 v20, 16, v240
  v_and_b32 v21, s78, v240
  v_lshlrev_b32 v22, 16, v241
  v_and_b32 v23, s78, v241
  v_lshlrev_b32 v24, 16, v238
  v_and_b32 v25, s78, v238
  v_lshlrev_b32 v26, 16, v239
  v_and_b32 v27, s78, v239
  v_lshlrev_b32 v28, 16, v242
  v_and_b32 v29, s78, v242
  v_lshlrev_b32 v30, 16, v243
  v_and_b32 v31, s78, v243
  v_lshlrev_b32 v32, 16, v2
  v_and_b32 v33, s78, v2
  v_lshlrev_b32 v34, 16, v3
  v_and_b32 v35, s78, v3
  v_lshlrev_b32 v36, 16, v244
  v_and_b32 v37, s78, v244
  v_lshlrev_b32 v38, 16, v245
  v_and_b32 v39, s78, v245
  v_lshlrev_b32 v40, 16, v4
  v_and_b32 v41, s78, v4
  v_lshlrev_b32 v42, 16, v5
  v_and_b32 v43, s78, v5
  v_lshlrev_b32 v44, 16, v246
  v_and_b32 v45, s78, v246
  v_lshlrev_b32 v46, 16, v247
  v_and_b32 v47, s78, v247
  v_lshlrev_b32 v48, 16, v6
  v_and_b32 v49, s78, v6
  v_lshlrev_b32 v50, 16, v7
  v_and_b32 v51, s78, v7
  v_lshlrev_b32 v52, 16, v248
  v_and_b32 v53, s78, v248
  v_lshlrev_b32 v54, 16, v249
  v_and_b32 v55, s78, v249
  v_mov_b32 v160, 162828
  s_mov_b32 s8, 0x40000
lw_43:
  ds_read_b32 v161, v160
  s_waitcnt lgkmcnt(0)
  v_readfirstlane_b32 s7, v161
  s_cmp_ge_u32 s7, 4
  s_cbranch_scc1 lwd_44
  s_sub_u32 s8, s8, 1
  s_cmp_lg_u32 s8, 0
  s_cbranch_scc1 lw_43
lwd_44:
  ds_read_b128 v[160:163], v13 offset:0
  ds_read_b128 v[164:167], v14 offset:1024
  ds_read_b128 v[168:171], v15 offset:2048
  ds_read_b128 v[172:175], v13 offset:3072
  ds_read_b128 v[176:179], v14 offset:4096
  ds_read_b128 v[180:183], v15 offset:5120
  ds_read_b128 v[184:187], v13 offset:6144
  ds_read_b128 v[188:191], v14 offset:7168
  ds_read_b128 v[192:195], v15 offset:8192
  ds_read_b128 v[196:199], v13 offset:9216
  ds_read_b128 v[200:203], v14 offset:10240
  ds_read_b128 v[204:207], v15 offset:11264
  ds_read_b128 v[208:211], v13 offset:12288
  ds_read_b128 v[212:215], v14 offset:13312
  ds_read_b128 v[216:219], v15 offset:14336
  s_waitcnt lgkmcnt(12)
  v_pk_add_f32 v[160:161], v[160:161], v[164:165]
  v_pk_add_f32 v[168:169], v[168:169], v[80:81]
  v_pk_add_f32 v[162:163], v[162:163], v[166:167]
  v_pk_add_f32 v[170:171], v[170:171], v[82:83]
  v_pk_add_f32 v[160:161], v[160:161], v[168:169]
  v_pk_add_f32 v[162:163], v[162:163], v[170:171]
  v_pk_fma_f32 v[16:17], v[160:161], v[20:21], v[16:17]
  v_pk_fma_f32 v[18:19], v[162:163], v[22:23], v[18:19]
  v_cvt_pk_bf16_f32 v20, v16, v17
  v_cvt_pk_bf16_f32 v21, v18, v19
  buffer_store_dwordx2 v[20:21], v1, s[68:71], s83 offen
  s_waitcnt lgkmcnt(9)
  v_pk_add_f32 v[172:173], v[172:173], v[176:177]
  v_pk_add_f32 v[180:181], v[180:181], v[96:97]
  v_pk_add_f32 v[174:175], v[174:175], v[178:179]
  v_pk_add_f32 v[182:183], v[182:183], v[98:99]
  v_pk_add_f32 v[172:173], v[172:173], v[180:181]
  v_pk_add_f32 v[174:175], v[174:175], v[182:183]
  v_pk_fma_f32 v[24:25], v[172:173], v[28:29], v[24:25]
  v_pk_fma_f32 v[26:27], v[174:175], v[30:31], v[26:27]
  v_cvt_pk_bf16_f32 v28, v24, v25
  v_cvt_pk_bf16_f32 v29, v26, v27
  buffer_store_dwordx2 v[28:29], v1, s[68:71], s85 offen
  s_waitcnt lgkmcnt(6)
  v_pk_add_f32 v[184:185], v[184:185], v[188:189]
  v_pk_add_f32 v[192:193], v[192:193], v[112:113]
  v_pk_add_f32 v[186:187], v[186:187], v[190:191]
  v_pk_add_f32 v[194:195], v[194:195], v[114:115]
  v_pk_add_f32 v[184:185], v[184:185], v[192:193]
  v_pk_add_f32 v[186:187], v[186:187], v[194:195]
  v_pk_fma_f32 v[32:33], v[184:185], v[36:37], v[32:33]
  v_pk_fma_f32 v[34:35], v[186:187], v[38:39], v[34:35]
  v_cvt_pk_bf16_f32 v36, v32, v33
  v_cvt_pk_bf16_f32 v37, v34, v35
  buffer_store_dwordx2 v[36:37], v1, s[68:71], s6 offen
  s_waitcnt lgkmcnt(3)
  v_pk_add_f32 v[196:197], v[196:197], v[200:201]
  v_pk_add_f32 v[204:205], v[204:205], v[128:129]
  v_pk_add_f32 v[198:199], v[198:199], v[202:203]
  v_pk_add_f32 v[206:207], v[206:207], v[130:131]
  v_pk_add_f32 v[196:197], v[196:197], v[204:205]
  v_pk_add_f32 v[198:199], v[198:199], v[206:207]
  v_pk_fma_f32 v[40:41], v[196:197], v[44:45], v[40:41]
  v_pk_fma_f32 v[42:43], v[198:199], v[46:47], v[42:43]
  v_cvt_pk_bf16_f32 v44, v40, v41
  v_cvt_pk_bf16_f32 v45, v42, v43
  buffer_store_dwordx2 v[44:45], v1, s[68:71], s12 offen
  s_waitcnt lgkmcnt(0)
  v_pk_add_f32 v[208:209], v[208:209], v[212:213]
  v_pk_add_f32 v[216:217], v[216:217], v[144:145]
  v_pk_add_f32 v[210:211], v[210:211], v[214:215]
  v_pk_add_f32 v[218:219], v[218:219], v[146:147]
  v_pk_add_f32 v[208:209], v[208:209], v[216:217]
  v_pk_add_f32 v[210:211], v[210:211], v[218:219]
  v_pk_fma_f32 v[48:49], v[208:209], v[52:53], v[48:49]
  v_pk_fma_f32 v[50:51], v[210:211], v[54:55], v[50:51]
  v_cvt_pk_bf16_f32 v52, v48, v49
  v_cvt_pk_bf16_f32 v53, v50, v51
  buffer_store_dwordx2 v[52:53], v1, s[68:71], s13 offen
k_end:
k_exit:
  s_endpgm
code_end:
.section .rodata,"a"
.p2align 6
.amdhsa_kernel recurrent_scan__grouped_kv_mqa__swiglu_ffn__prompt_kernel
  .amdhsa_next_free_vgpr 256
  .amdhsa_next_free_sgpr 102
  .amdhsa_accum_offset 256
  .amdhsa_group_segment_fixed_size 0
  .amdhsa_kernarg_size 96
  .amdhsa_user_sgpr_count 2
  .amdhsa_user_sgpr_kernarg_segment_ptr 1
  .amdhsa_system_sgpr_workgroup_id_x 1
.end_amdhsa_kernel
```
